```python
import torch

def _softmax(x, axis=-1):
    return torch.softmax(x, dim=axis)
def _gelu(x):
    return torch.nn.functional.gelu(x, approximate="tanh")
def _silu(x):
    return torch.nn.functional.silu(x)
def _sigmoid(x):
    return torch.sigmoid(x)
def _layernorm(x, axis=-1, eps=1e-5):
    m = x.mean(dim=axis, keepdim=True)
    v = x.var(dim=axis, keepdim=True, unbiased=False)
    return (x - m) / torch.sqrt(v + eps)
def _scatter_add(tgt, idx, src, axis=0):
    return tgt.clone().index_add_(axis, idx, src)
def _segment_sum(src, seg, n):
    out = torch.zeros((n,) + src.shape[1:], dtype=src.dtype)
    return out.index_add_(0, seg, src)
def _pad(x, pw):
    flat = tuple(v for pair in reversed(pw) for v in pair)
    return torch.nn.functional.pad(x, flat)

kernel_name = 'gather_scatter__edge_featured_mpnn_egc__graph'

def setup_inputs():

    _w = (lambda a: (lambda t: t.to(torch.bfloat16) if t.is_floating_point() else t)(torch.as_tensor(a)))
    N, deg, D, De = 10000, 16, 128, max(0, 1)
    E = N * deg
    return {
        "x": _w((lambda *s: torch.randn(*s, dtype=torch.bfloat16) * 0.1)(N, D)),
        "e_attr": _w((lambda *s: torch.randn(*s, dtype=torch.bfloat16) * 0.1)(E, De)),
        "src": _w((lambda lo, hi, *s: torch.randint(lo, hi, s))(0, N, E).to(torch.int64)),
        "dst": _w((lambda lo, hi, *s: torch.randint(lo, hi, s))(0, N, E).to(torch.int64)),
        "u_w": _w((lambda *s: torch.randn(*s, dtype=torch.bfloat16) * 0.05)(D, D)),
        "v_w": _w((lambda *s: torch.randn(*s, dtype=torch.bfloat16) * 0.05)(D, D)),
        "g_w": _w((lambda *s: torch.randn(*s, dtype=torch.bfloat16) * 0.1)(2 * D + De, D)),
    }

def reference(x, e_attr, src, dst, u_w, v_w, g_w):
    N, D = x.shape
    g_in = torch.concatenate([x[dst], x[src], e_attr], axis=-1)
    eta = _sigmoid(g_in @ g_w)
    hv = x @ v_w
    msg = eta * hv[src]
    agg = _segment_sum(msg, dst, N)
    return _silu(x @ u_w + agg)
```

```asm
; @launch grid=(256,1,1) block=(1024,1,1) lds=160512
.amdgcn_target "amdgcn-amd-amdhsa--gfx950"
.text
.globl gather_scatter__edge_featured_mpnn_egc__graph_kernel
.p2align 8
.type gather_scatter__edge_featured_mpnn_egc__graph_kernel,@function
gather_scatter__edge_featured_mpnn_egc__graph_kernel:
    s_load_dwordx16 s[4:19], s[0:1], 0
    s_load_dwordx2 s[28:29], s[0:1], 72
    s_cmp_ge_u32 s2, 256
    s_cbranch_scc1 L_end
    s_cmp_ge_u32 s2, 16
    s_cbranch_scc1 L_nol2
    v_cmp_gt_u32 vcc, 64, v0
    s_cbranch_vccz L_nol2
    s_getpc_b64 s[46:47]
    v_lshlrev_b32 v2, 7, v0
    v_mov_b32 v3, s47
    v_add_co_u32 v2, vcc, s46, v2
    s_nop 1
    v_addc_co_u32 v3, vcc, 0, v3, vcc
    global_load_dword v127, v[2:3], off offset:960
L_nol2:
    s_mul_i32 s46, s2, 2500
    v_lshl_add_u32 v3, v0, 2, s46
    v_cmp_gt_u32 vcc, 625, v0
    v_lshrrev_b32 v4, 1, v3
    v_mov_b32 v119, 0
    s_mov_b64 s[70:71], vcc
    s_cbranch_vccz L_noedge
    s_mov_b64 exec, vcc
    s_waitcnt lgkmcnt(0)
    global_load_dword v52, v3, s[10:11] nt
    global_load_dword v54, v3, s[8:9] nt
    global_load_ushort v56, v4, s[6:7] nt
    global_load_dwordx2 v[72:73], v119, s[28:29] sc1
    s_mov_b64 exec, -1
L_noedge:
    v_add_u32 v0, 384, v0
    v_and_b32 v0, 0x3ff, v0
    v_lshrrev_b32 v2, 6, v0
    v_and_b32 v1, 63, v0
    v_readfirstlane_b32 s3, v2
    v_lshlrev_b32 v8, 2, v0
    v_mov_b32 v12, 16383
    v_cmp_le_u32 vcc, 3648, v8
    s_and_b32 s42, s2, 3
    s_lshr_b32 s43, s2, 2
    s_mul_i32 s44, s43, 157
    v_cndmask_b32 v9, 0, v12, vcc
    ds_write_b32 v8, v9
    v_mov_b32 v119, 0
    v_mov_b32 v120, 1
    s_mov_b32 s30, 0x10000000
    s_mov_b32 s31, 0x20000
    s_cmp_ge_u32 s3, 6
    s_cbranch_scc0 L_note
L_e0:
    s_setprio 2
    v_mov_b32 v16, 0
    v_mov_b32 v17, 0
    v_mov_b32 v18, 0
    v_mov_b32 v19, 0xffffff
    v_lshlrev_b32 v9, 4, v0
    v_subrev_u32 v9, 6144, v9
    v_min_u32 v10, 8176, v9
    ds_write_b128 v10, v[16:19] offset:35072
    v_mov_b32 v13, v12
    v_mov_b32 v14, v12
    v_mov_b32 v15, v12
    s_waitcnt lgkmcnt(0)
    s_barrier
    ds_write_b128 v9, v[12:15] offset:4096
    ds_write_b128 v9, v[12:15] offset:14336
    ds_write_b128 v9, v[12:15] offset:24576
    v_lshrrev_b32 v9, 2, v9
    ds_write_b32 v9, v12 offset:32512
    s_branch L_e1
L_note:
    v_lshrrev_b32 v11, 4, v1
    s_cmp_ge_u32 s3, 4
    s_cbranch_scc1 L_l0
    v_xor_b32 v4, v11, v1
    v_and_b32 v4, 15, v4
    v_lshlrev_b32 v4, 4, v4
    v_lshl_add_u32 v4, v11, 8, v4
    s_mul_i32 s73, s42, 5
    s_add_u32 s73, s73, 1
    s_lshr_b32 s73, s73, 1
    s_add_u32 s73, s73, s3
    s_cmp_ge_u32 s73, 10
    s_cselect_b32 s46, 10, 0
    s_sub_u32 s73, s73, s46
    s_mov_b32 s75, s73
    s_lshl_b32 s46, s73, 12
    s_lshl_b32 s48, s44, 8
    s_add_u32 s48, s48, s46
    v_add_u32 v4, s48, v4
    v_xor_b32 v5, 64, v4
    v_xor_b32 v6, 128, v4
    v_xor_b32 v7, 192, v4
    s_add_u32 m0, s46, 76032
    s_mov_b32 s22, 2560000
    s_mov_b32 s23, 0x20000
    s_waitcnt lgkmcnt(0)
    s_mov_b32 s20, s4
    s_mov_b32 s21, s5
    s_barrier
    buffer_load_dwordx4 v4, s[20:23], 0 offen offset:0 lds
    buffer_load_dwordx4 v5, s[20:23], 0 offen offset:1024 lds
    buffer_load_dwordx4 v6, s[20:23], 0 offen offset:2048 lds
    buffer_load_dwordx4 v7, s[20:23], 0 offen offset:3072 lds
L_warm:
    s_branch L_common
L_l0:
    s_lshl_b32 s46, s42, 6
    v_lshrrev_b32 v9, 2, v1
    v_and_b32 v12, 2, v11
    v_xor_b32 v12, v12, v1
    v_and_b32 v12, 3, v12
    v_lshlrev_b32 v12, 4, v12
    v_lshl_add_u32 v12, v9, 8, v12
    v_add_u32 v12, s46, v12
    s_cmp_eq_u32 s3, 4
    s_cbranch_scc1 L_l4
    s_waitcnt lgkmcnt(0)
    s_barrier
    s_branch L_warm
L_l4:
    s_setprio 3
    s_bfe_u32 s47, s2, 0x40003
    s_lshl_b32 s47, s47, 12
    s_add_u32 s47, s47, s46
    v_lshlrev_b32 v10, 8, v1
    v_add_u32 v10, s47, v10
    s_bitcmp1_b32 s2, 7
    s_cselect_b32 s48, 0x7fff, -1
    v_and_b32 v10, s48, v10
    v_and_b32 v19, 7, v1
    v_lshlrev_b32 v16, 3, v19
    s_add_u32 s47, s46, 65536
    v_add_u32 v16, s47, v16
    s_mov_b32 s50, 43264
    s_waitcnt lgkmcnt(0)
    s_bitcmp1_b32 s2, 6
    s_cselect_b64 s[52:53], s[12:13], s[14:15]
    s_bitcmp1_b32 s2, 7
    s_cselect_b64 s[52:53], s[52:53], s[16:17]
    s_mov_b64 exec, 0xffff
    global_load_dword v127, v10, s[52:53]
    s_mov_b64 exec, -1
    global_load_dwordx2 v[16:17], v16, s[16:17]
    s_add_u32 s52, s16, 32768
    s_addc_u32 s53, s17, 0
    s_barrier
    v_add_u32 v13, 3072, v12
    v_add_u32 v14, 6144, v12
    v_add_u32 v15, 9216, v12
    s_branch L_spun1
L_spin1:
    s_sleep 1
L_spun1:
    ds_read_b32 v8, v119 offset:1164
    s_waitcnt lgkmcnt(0)
    v_readfirstlane_b32 s55, v8
    s_cmp_ge_i32 s55, 8
    s_cbranch_scc0 L_spin1
L_wa:
    s_mov_b32 m0, s50
    s_add_u32 s50, s50, 4096
    global_load_lds_dwordx4 v12, s[52:53] offset:0
    global_load_lds_dwordx4 v13, s[52:53] offset:1024
    global_load_lds_dwordx4 v14, s[52:53] offset:2048
    global_load_lds_dwordx4 v15, s[52:53] offset:3072
    s_add_u32 s52, s52, 16384
    s_addc_u32 s53, s53, 0
    s_cmp_eq_u32 s50, 51456
    s_cselect_b64 s[52:53], s[14:15], s[52:53]
    s_cmp_lt_u32 s50, 59648
    s_cbranch_scc1 L_wa
    s_mov_b64 exec, 1
    ds_add_u32 v119, v120 offset:1164
    s_mov_b64 exec, -1
    s_mov_b32 s46, 0xbfb8aa3b
    s_waitcnt vmcnt(16)
    v_lshlrev_b32 v8, 16, v16
    v_and_b32 v9, 0xffff0000, v16
    v_lshlrev_b32 v10, 16, v17
    v_and_b32 v11, 0xffff0000, v17
    v_mul_f32 v8, s46, v8
    v_mul_f32 v9, s46, v9
    v_mul_f32 v10, s46, v10
    v_mul_f32 v11, s46, v11
    v_lshlrev_b32 v19, 4, v19
    ds_write_b128 v19, v[8:11] offset:1920
    s_waitcnt vmcnt(0)
    ds_write_b32 v119, v120 offset:1160
    s_setprio 0
L_common:
    s_mov_b32 s20, s4
    s_mov_b32 s21, s5
    s_mov_b32 s22, 2560000
    s_mov_b32 s23, 0x20000
    s_add_u32 s45, s44, 157
    s_min_u32 s45, s45, 10000
    s_mov_b32 s24, s18
    s_mov_b32 s25, s19
    s_lshl_b32 s26, s45, 8
    s_mov_b32 s27, 0x20000
    s_mul_i32 s54, s42, 1280000
    s_add_u32 s54, s54, 1048576
    s_add_u32 s32, s28, s54
    s_addc_u32 s33, s29, 0
    s_lshl_b32 s34, s45, 7
    s_mov_b32 s35, 0x20000
    s_mov_b32 s36, s32
    s_and_b32 s37, s33, 0xffff
    s_or_b32 s37, s37, 0x800000
    s_mov_b32 s38, 10000
    s_mov_b32 s39, 0x20000
    s_mov_b32 s72, 0x53800000
    s_mov_b32 s74, 0xabb8aa3b
    s_mov_b32 s76, 0
    s_mov_b32 s80, 0x7f800000
    s_mov_b32 s81, 0
    s_mov_b32 s59, 0
    s_mov_b32 s54, 0x456879ad
    s_mov_b32 s55, 0x3210bcfe
    s_lshl_b32 s58, s3, 2
    s_lshr_b64 s[54:55], s[54:55], s58
    s_and_b32 s58, s54, 15
    s_lshl_b32 s54, s3, 3
    s_lshr_b32 s54, 0x12111013, s54
    s_and_b32 s54, s54, 31
    s_lshr_b32 s55, s3, 2
    s_cmp_eq_u32 s55, 2
    s_cselect_b32 s57, s54, 0
    v_bfe_u32 v20, v1, 2, 2
    v_lshrrev_b32 v21, 4, v1
    v_cmp_eq_u32 vcc, v20, v21
    v_and_b32 v22, 3, v1
    v_mov_b32 v23, 0x3f80
    v_cndmask_b32 v2, 4, v22, vcc
    v_cmp_eq_u32 vcc, 0, v2
    v_mov_b32 v24, 0
    v_and_b32 v121, 7, v1
    v_cndmask_b32 v32, 0, v23, vcc
    v_cmp_eq_u32 vcc, 1, v2
    v_mov_b32 v25, 0
    v_lshlrev_b32 v37, 4, v121
    v_cndmask_b32 v33, 0, v23, vcc
    v_cmp_eq_u32 vcc, 2, v2
    v_mov_b32 v26, 0
    v_lshrrev_b32 v116, 3, v1
    v_cndmask_b32 v34, 0, v23, vcc
    v_cmp_eq_u32 vcc, 3, v2
    v_mov_b32 v27, 0
    v_lshlrev_b32 v116, 2, v116
    v_cndmask_b32 v35, 0, v23, vcc
    v_mov_b32 v39, v37
    v_mov_b32 v41, v37
    v_mov_b32 v43, v37
    v_mov_b32 v45, v37
    v_mov_b32 v47, v37
    v_mov_b32 v49, v37
    v_mov_b32 v51, v37
    v_mov_b32 v122, 0
    v_mov_b32 v123, 0
    v_mov_b32 v124, 0
    v_mov_b32 v125, 0
    s_lshl_b32 s54, s44, 8
    s_lshl_b32 s55, s42, 6
    s_add_u32 s54, s54, s55
    v_lshlrev_b32 v117, 3, v121
    v_add_u32 v117, s54, v117
    v_add_u32 v118, 116992, v37
    s_cmp_ge_u32 s3, 8
    s_cbranch_scc1 L_c0
L_t0:
    s_and_b32 s54, s3, 3
    s_cmp_ge_u32 s3, 4
    s_cselect_b32 s73, s54, s73
    v_bfe_u32 v20, v1, 2, 2
    v_lshrrev_b32 v21, 4, v1
    v_and_b32 v22, 3, v1
    v_and_b32 v23, 15, v1
    v_xor_b32 v122, v23, v21
    v_lshlrev_b32 v122, 4, v122
    v_lshl_add_u32 v122, v23, 8, v122
    s_lshl_b32 s46, s73, 12
    s_add_u32 s46, s46, 76032
    v_add_u32 v122, s46, v122
    v_lshl_add_u32 v2, v21, 3, v20
    v_lshlrev_b32 v2, 6, v2
    v_lshl_add_u32 v2, v22, 3, v2
    v_and_b32 v20, 1, v21
    v_lshl_add_u32 v2, v20, 5, v2
    v_add_u32 v2, 43264, v2
    v_xor_b32 v3, 32, v2
    v_lshlrev_b32 v21, 4, v21
    s_lshl_b32 s47, s73, 4
    s_add_u32 s47, s47, s44
    s_lshl_b32 s47, s47, 7
    v_lshl_add_u32 v48, v23, 7, v21
    v_add_u32 v48, s47, v48
    v_lshrrev_b32 v20, 2, v21
    v_add_u32 v22, s73, v20
    v_cmp_le_u32 vcc, 10, v22
    v_lshlrev_b32 v123, 7, v23
    v_lshl_add_u32 v123, v21, 9, v123
    v_add_u32 v123, s47, v123
    v_subrev_u32 v22, 20480, v123
    v_cndmask_b32 v123, v123, v22, vcc
    v_add_u32 v22, s3, v20
    v_cmp_gt_u32 vcc, 10, v22
    s_nop 1
    v_cndmask_b32 v123, -16, v123, vcc
    s_mul_i32 s48, s54, 4352
    s_add_u32 s48, s48, 116992
    v_mul_u32_u24 v49, 272, v23
    v_add3_u32 v49, v49, v21, s48
    s_mov_b32 s50, 0x3fb8aa3b
    s_mov_b32 s51, 0x537fa787
    s_cmp_ge_u32 s3, 4
    s_cbranch_scc1 L_pu
    s_cmp_ge_u32 s75, 6
    s_cselect_b32 s53, -6, 4
    s_add_u32 s75, s75, s53
    s_lshl_b32 s53, s53, 12
    v_add_u32 v4, s53, v4
    v_add_u32 v5, s53, v5
    v_add_u32 v6, s53, v6
    v_add_u32 v7, s53, v7
    s_add_u32 m0, m0, s53
    s_branch L_spun2
L_spin2:
    s_sleep 1
L_spun2:
    ds_read_b32 v51, v119 offset:1164
    s_waitcnt lgkmcnt(0)
    v_readfirstlane_b32 s55, v51
    s_cmp_ge_i32 s55, 9
    s_cbranch_scc0 L_spin2
    buffer_load_dwordx4 v4, s[20:23], 0 offen offset:0 lds
    buffer_load_dwordx4 v5, s[20:23], 0 offen offset:1024 lds
    buffer_load_dwordx4 v6, s[20:23], 0 offen offset:2048 lds
    buffer_load_dwordx4 v7, s[20:23], 0 offen offset:3072 lds
    s_cmp_ge_u32 s3, 2
    s_cbranch_scc1 L_two
    s_cmp_ge_u32 s75, 6
    s_cselect_b32 s53, -6, 4
    s_add_u32 s75, s75, s53
    s_lshl_b32 s53, s53, 12
    v_add_u32 v4, s53, v4
    v_add_u32 v5, s53, v5
    v_add_u32 v6, s53, v6
    v_add_u32 v7, s53, v7
    s_add_u32 m0, m0, s53
    s_nop 0
    buffer_load_dwordx4 v4, s[20:23], 0 offen offset:0 lds
    buffer_load_dwordx4 v5, s[20:23], 0 offen offset:1024 lds
    buffer_load_dwordx4 v6, s[20:23], 0 offen offset:2048 lds
    buffer_load_dwordx4 v7, s[20:23], 0 offen offset:3072 lds
    s_waitcnt vmcnt(8)
    s_branch L_three
L_two:
    s_waitcnt vmcnt(4)
L_three:
    v_mov_b32 v4, v122
    v_xor_b32 v5, 64, v122
    v_xor_b32 v6, 128, v122
    v_xor_b32 v7, 192, v122
    s_mov_b32 s49, s54
    s_mov_b32 s75, s73
    s_branch L_spun3
L_spin3:
    s_sleep 1
L_spun3:
    ds_read_b32 v51, v119 offset:1160
    s_waitcnt lgkmcnt(0)
    v_readfirstlane_b32 s55, v51
    s_cmp_ge_i32 s55, 1
    s_cbranch_scc0 L_spin3
    ds_read_b64_tr_b16 v[52:53], v2 offset:0
    ds_read_b64_tr_b16 v[54:55], v2 offset:256
    ds_read_b64_tr_b16 v[56:57], v2 offset:8192
    ds_read_b64_tr_b16 v[58:59], v2 offset:8448
    ds_read_b64_tr_b16 v[60:61], v2 offset:2048
    ds_read_b64_tr_b16 v[62:63], v2 offset:2304
    ds_read_b64_tr_b16 v[64:65], v2 offset:10240
    ds_read_b64_tr_b16 v[66:67], v2 offset:10496
    ds_read_b64_tr_b16 v[68:69], v2 offset:4096
    ds_read_b64_tr_b16 v[70:71], v2 offset:4352
    ds_read_b64_tr_b16 v[72:73], v2 offset:12288
    ds_read_b64_tr_b16 v[74:75], v2 offset:12544
    ds_read_b64_tr_b16 v[76:77], v2 offset:6144
    ds_read_b64_tr_b16 v[78:79], v2 offset:6400
    ds_read_b64_tr_b16 v[80:81], v2 offset:14336
    ds_read_b64_tr_b16 v[82:83], v2 offset:14592
    ds_read_b64_tr_b16 v[84:85], v3 offset:0
    ds_read_b64_tr_b16 v[86:87], v3 offset:256
    ds_read_b64_tr_b16 v[88:89], v3 offset:8192
    ds_read_b64_tr_b16 v[90:91], v3 offset:8448
    ds_read_b64_tr_b16 v[92:93], v3 offset:2048
    ds_read_b64_tr_b16 v[94:95], v3 offset:2304
    ds_read_b64_tr_b16 v[96:97], v3 offset:10240
    ds_read_b64_tr_b16 v[98:99], v3 offset:10496
    ds_read_b64_tr_b16 v[100:101], v3 offset:4096
    ds_read_b64_tr_b16 v[102:103], v3 offset:4352
    ds_read_b64_tr_b16 v[104:105], v3 offset:12288
    ds_read_b64_tr_b16 v[106:107], v3 offset:12544
    ds_read_b64_tr_b16 v[108:109], v3 offset:6144
    ds_read_b64_tr_b16 v[110:111], v3 offset:6400
    ds_read_b64_tr_b16 v[112:113], v3 offset:14336
    ds_read_b64_tr_b16 v[114:115], v3 offset:14592
L_tile1:
    s_mov_b64 exec, 1
    ds_add_u32 v119, v120 offset:1204
    s_mov_b64 exec, -1
    ds_read_b128 v[8:11], v4
    ds_read_b128 v[12:15], v5
    ds_read_b128 v[16:19], v6
    ds_read_b128 v[20:23], v7
    s_cmp_ge_u32 s75, 6
    s_cselect_b32 s53, -6, 4
    s_add_u32 s75, s75, s53
    s_lshl_b32 s53, s53, 12
    v_add_u32 v4, s53, v4
    v_add_u32 v5, s53, v5
    v_add_u32 v6, s53, v6
    v_add_u32 v7, s53, v7
    s_waitcnt lgkmcnt(3)
    v_mfma_f32_16x16x32_bf16 v[24:27], v[52:55], v[8:11], 0
    v_mfma_f32_16x16x32_bf16 v[28:31], v[56:59], v[8:11], 0
    s_waitcnt lgkmcnt(2)
    v_mfma_f32_16x16x32_bf16 v[24:27], v[60:63], v[12:15], v[24:27]
    v_mfma_f32_16x16x32_bf16 v[28:31], v[64:67], v[12:15], v[28:31]
    s_waitcnt lgkmcnt(1)
    v_mfma_f32_16x16x32_bf16 v[24:27], v[68:71], v[16:19], v[24:27]
    v_mfma_f32_16x16x32_bf16 v[28:31], v[72:75], v[16:19], v[28:31]
    s_waitcnt lgkmcnt(0)
    v_mfma_f32_16x16x32_bf16 v[24:27], v[76:79], v[20:23], v[24:27]
    v_mfma_f32_16x16x32_bf16 v[28:31], v[80:83], v[20:23], v[28:31]
    v_mfma_f32_16x16x32_bf16 v[32:35], v[84:87], v[8:11], 0
    v_mfma_f32_16x16x32_bf16 v[36:39], v[88:91], v[8:11], 0
    v_mfma_f32_16x16x32_bf16 v[32:35], v[92:95], v[12:15], v[32:35]
    v_mfma_f32_16x16x32_bf16 v[36:39], v[96:99], v[12:15], v[36:39]
    v_mfma_f32_16x16x32_bf16 v[32:35], v[100:103], v[16:19], v[32:35]
    v_mfma_f32_16x16x32_bf16 v[36:39], v[104:107], v[16:19], v[36:39]
    v_mfma_f32_16x16x32_bf16 v[32:35], v[108:111], v[20:23], v[32:35]
    v_mfma_f32_16x16x32_bf16 v[36:39], v[112:115], v[20:23], v[36:39]
    v_mul_f32 v24, s50, v24
    v_mul_f32 v25, s50, v25
    v_mul_f32 v26, s50, v26
    v_mul_f32 v27, s50, v27
    v_exp_f32 v24, v24
    v_exp_f32 v25, v25
    v_exp_f32 v26, v26
    v_exp_f32 v27, v27
    v_mul_f32 v28, s51, v28
    v_mul_f32 v29, s51, v29
    v_mul_f32 v30, s51, v30
    v_mul_f32 v31, s51, v31
    v_mul_f32 v28, v24, v28
    v_mul_f32 v29, v25, v29
    v_mul_f32 v30, v26, v30
    v_mul_f32 v31, v27, v31
    v_cvt_pk_bf16_f32 v40, v24, v28
    v_cvt_pk_bf16_f32 v41, v25, v29
    v_cvt_pk_bf16_f32 v42, v26, v30
    v_cvt_pk_bf16_f32 v43, v27, v31
    buffer_store_dwordx4 v[40:43], v48, s[32:35], 0 offen offset:0 sc1
    v_mul_f32 v32, s50, v32
    v_mul_f32 v33, s50, v33
    v_mul_f32 v34, s50, v34
    v_mul_f32 v35, s50, v35
    v_exp_f32 v32, v32
    v_exp_f32 v33, v33
    v_exp_f32 v34, v34
    v_exp_f32 v35, v35
    v_mul_f32 v36, s51, v36
    v_mul_f32 v37, s51, v37
    v_mul_f32 v38, s51, v38
    v_mul_f32 v39, s51, v39
    v_mul_f32 v36, v32, v36
    v_mul_f32 v37, v33, v37
    v_mul_f32 v38, v34, v38
    v_mul_f32 v39, v35, v39
    v_cvt_pk_bf16_f32 v44, v32, v36
    v_cvt_pk_bf16_f32 v45, v33, v37
    v_cvt_pk_bf16_f32 v46, v34, v38
    v_cvt_pk_bf16_f32 v47, v35, v39
    buffer_store_dwordx4 v[44:47], v48, s[32:35], 0 offen offset:64 sc1
    v_min3_f32 v50, v24, v25, v26
    v_min3_f32 v50, v50, v27, v32
    v_min3_f32 v50, v50, v33, v34
    v_min_f32 v50, v50, v35
    v_cmp_gt_f32 vcc, 0x17800000, v50
    s_cbranch_vccnz L_mark
L_markback:
    s_ashr_i32 s53, s53, 1
    v_add_u32 v48, s53, v48
    s_add_u32 s49, s49, 4
    s_cmp_ge_u32 s49, 10
    s_cbranch_scc1 L_tiles1
    s_waitcnt vmcnt(6)
    s_cmp_lt_u32 s49, 6
    s_cbranch_scc1 L_tile1
    s_waitcnt vmcnt(4)
    s_cmp_ge_u32 s49, 8
    s_cbranch_scc1 L_xdone
    s_waitcnt vmcnt(2)
L_xdone:
    s_mov_b64 exec, 1
    ds_add_u32 v119, v120 offset:1180
    s_mov_b64 exec, -1
    s_branch L_tile1
L_tiles1:
    v_mov_b32 v17, v123
    s_branch L_tdone
L_tsig:
L_spin4:
    ds_read_b32 v13, v119 offset:1216
    s_waitcnt lgkmcnt(0)
    v_readfirstlane_b32 s55, v13
    s_cmp_ge_i32 s55, 2
    s_cbranch_scc0 L_spin4
    ds_read_b64 v[8:9], v119 offset:1184
    ds_read_b64 v[10:11], v119 offset:1184
    v_lshlrev_b32 v12, 4, v1
    s_lshl_b32 s46, s42, 6
    s_add_u32 s46, s46, s43
    s_lshl_b32 s46, s46, 7
    s_add_u32 s46, s46, 7340032
    s_mov_b64 exec, 1
    s_waitcnt vmcnt(0)
    ds_add_rtn_u32 v13, v119, v120 offset:1152
    s_waitcnt lgkmcnt(0)
    v_cmp_eq_u32 vcc, 3, v13
    s_cbranch_vccz L_nosig
    s_mov_b64 exec, 15
    buffer_store_dwordx4 v[8:11], v12, s[28:31], s46 offen sc1
    s_mov_b64 exec, -1
    s_setprio 3
    v_lshlrev_b32 v12, 7, v1
    s_lshl_b32 s46, s42, 13
    s_add_u32 s46, s46, 7340032
    buffer_load_dword v127, v17, s[32:35], 0 offen sc1
    s_waitcnt vmcnt(0)
L_poll:
    buffer_load_dwordx2 v[10:11], v12, s[28:31], s46 offen sc1
    s_add_u32 s59, s59, 1
    s_cmp_ge_u32 s59, 32768
    s_cbranch_scc1 L_pgiveup
    s_waitcnt vmcnt(0)
    v_cmp_ne_u64 vcc, v[8:9], v[10:11]
    s_mov_b64 exec, vcc
    s_cbranch_vccnz L_poll
L_pollok:
    s_mov_b64 exec, -1
    ds_write_b32 v119, v120 offset:1176
    s_setprio 0
    s_branch L_join
L_nosig:
    s_mov_b64 exec, -1
    buffer_load_dword v127, v17, s[32:35], 0 offen sc1
    s_branch L_join
L_pu:
    s_cmp_eq_u32 s3, 5
    s_cbranch_scc0 L_now2
    s_mov_b64 s[52:53], s[16:17]
    s_mov_b32 s50, 59648
    v_add_u32 v13, 3072, v12
    v_add_u32 v14, 6144, v12
    v_add_u32 v15, 9216, v12
    s_branch L_spun5
L_spin5:
    s_sleep 1
L_spun5:
    ds_read_b32 v51, v119 offset:1160
    s_waitcnt lgkmcnt(0)
    v_readfirstlane_b32 s55, v51
    s_cmp_ge_i32 s55, 1
    s_cbranch_scc0 L_spin5
L_wb:
    s_mov_b32 m0, s50
    s_add_u32 s50, s50, 4096
    global_load_lds_dwordx4 v12, s[52:53] offset:0
    global_load_lds_dwordx4 v13, s[52:53] offset:1024
    global_load_lds_dwordx4 v14, s[52:53] offset:2048
    global_load_lds_dwordx4 v15, s[52:53] offset:3072
    s_add_u32 s52, s52, 16384
    s_addc_u32 s53, s53, 0
    s_cmp_eq_u32 s50, 67840
    s_cselect_b64 s[52:53], s[12:13], s[52:53]
    s_cmp_lt_u32 s50, 76032
    s_cbranch_scc1 L_wb
    s_waitcnt vmcnt(0)
    s_mov_b64 exec, 1
    ds_add_u32 v119, v120 offset:1180
    s_mov_b64 exec, -1
L_now2:
    s_mov_b32 s50, 0xbfb8aa3b
    v_mov_b32 v4, v122
    v_xor_b32 v5, 64, v122
    v_xor_b32 v6, 128, v122
    v_xor_b32 v7, 192, v122
    s_mov_b32 s49, s54
    s_mov_b32 s75, s73
    s_branch L_spun6
L_spin6:
    s_sleep 1
L_spun6:
    ds_read_b32 v51, v119 offset:1180
    s_waitcnt lgkmcnt(0)
    v_readfirstlane_b32 s55, v51
    s_cmp_ge_i32 s55, 5
    s_cbranch_scc0 L_spin6
    ds_read_b64_tr_b16 v[52:53], v2 offset:16384
    ds_read_b64_tr_b16 v[54:55], v2 offset:16640
    ds_read_b64_tr_b16 v[56:57], v2 offset:24576
    ds_read_b64_tr_b16 v[58:59], v2 offset:24832
    ds_read_b64_tr_b16 v[60:61], v2 offset:18432
    ds_read_b64_tr_b16 v[62:63], v2 offset:18688
    ds_read_b64_tr_b16 v[64:65], v2 offset:26624
    ds_read_b64_tr_b16 v[66:67], v2 offset:26880
    ds_read_b64_tr_b16 v[68:69], v2 offset:20480
    ds_read_b64_tr_b16 v[70:71], v2 offset:20736
    ds_read_b64_tr_b16 v[72:73], v2 offset:28672
    ds_read_b64_tr_b16 v[74:75], v2 offset:28928
    ds_read_b64_tr_b16 v[76:77], v2 offset:22528
    ds_read_b64_tr_b16 v[78:79], v2 offset:22784
    ds_read_b64_tr_b16 v[80:81], v2 offset:30720
    ds_read_b64_tr_b16 v[82:83], v2 offset:30976
    ds_read_b64_tr_b16 v[84:85], v3 offset:16384
    ds_read_b64_tr_b16 v[86:87], v3 offset:16640
    ds_read_b64_tr_b16 v[88:89], v3 offset:24576
    ds_read_b64_tr_b16 v[90:91], v3 offset:24832
    ds_read_b64_tr_b16 v[92:93], v3 offset:18432
    ds_read_b64_tr_b16 v[94:95], v3 offset:18688
    ds_read_b64_tr_b16 v[96:97], v3 offset:26624
    ds_read_b64_tr_b16 v[98:99], v3 offset:26880
    ds_read_b64_tr_b16 v[100:101], v3 offset:20480
    ds_read_b64_tr_b16 v[102:103], v3 offset:20736
    ds_read_b64_tr_b16 v[104:105], v3 offset:28672
    ds_read_b64_tr_b16 v[106:107], v3 offset:28928
    ds_read_b64_tr_b16 v[108:109], v3 offset:22528
    ds_read_b64_tr_b16 v[110:111], v3 offset:22784
    ds_read_b64_tr_b16 v[112:113], v3 offset:30720
    ds_read_b64_tr_b16 v[114:115], v3 offset:30976
L_tile2:
    ds_read_b128 v[8:11], v4
    ds_read_b128 v[12:15], v5
    ds_read_b128 v[16:19], v6
    ds_read_b128 v[20:23], v7
    s_cmp_ge_u32 s75, 6
    s_cselect_b32 s53, -6, 4
    s_add_u32 s75, s75, s53
    s_lshl_b32 s53, s53, 12
    v_add_u32 v4, s53, v4
    v_add_u32 v5, s53, v5
    v_add_u32 v6, s53, v6
    v_add_u32 v7, s53, v7
    s_waitcnt lgkmcnt(3)
    v_mfma_f32_16x16x32_bf16 v[24:27], v[52:55], v[8:11], 0
    v_mfma_f32_16x16x32_bf16 v[28:31], v[56:59], v[8:11], 0
    s_waitcnt lgkmcnt(2)
    v_mfma_f32_16x16x32_bf16 v[24:27], v[60:63], v[12:15], v[24:27]
    v_mfma_f32_16x16x32_bf16 v[28:31], v[64:67], v[12:15], v[28:31]
    s_waitcnt lgkmcnt(1)
    v_mfma_f32_16x16x32_bf16 v[24:27], v[68:71], v[16:19], v[24:27]
    v_mfma_f32_16x16x32_bf16 v[28:31], v[72:75], v[16:19], v[28:31]
    s_waitcnt lgkmcnt(0)
    v_mfma_f32_16x16x32_bf16 v[24:27], v[76:79], v[20:23], v[24:27]
    v_mfma_f32_16x16x32_bf16 v[28:31], v[80:83], v[20:23], v[28:31]
    v_mfma_f32_16x16x32_bf16 v[32:35], v[84:87], v[8:11], 0
    v_mfma_f32_16x16x32_bf16 v[36:39], v[88:91], v[8:11], 0
    v_mfma_f32_16x16x32_bf16 v[32:35], v[92:95], v[12:15], v[32:35]
    v_mfma_f32_16x16x32_bf16 v[36:39], v[96:99], v[12:15], v[36:39]
    v_mfma_f32_16x16x32_bf16 v[32:35], v[100:103], v[16:19], v[32:35]
    v_mfma_f32_16x16x32_bf16 v[36:39], v[104:107], v[16:19], v[36:39]
    v_mfma_f32_16x16x32_bf16 v[32:35], v[108:111], v[20:23], v[32:35]
    v_mfma_f32_16x16x32_bf16 v[36:39], v[112:115], v[20:23], v[36:39]
    v_mul_f32 v24, s50, v24
    v_mul_f32 v25, s50, v25
    v_mul_f32 v26, s50, v26
    v_mul_f32 v27, s50, v27
    s_nop 1
    ds_write_b128 v49, v[24:27] offset:0
    ds_write_b128 v49, v[28:31] offset:128
    v_mul_f32 v32, s50, v32
    v_mul_f32 v33, s50, v33
    v_mul_f32 v34, s50, v34
    v_mul_f32 v35, s50, v35
    ds_write_b128 v49, v[32:35] offset:64
    ds_write_b128 v49, v[36:39] offset:192
    v_add_u32 v49, 17408, v49
    s_add_u32 s49, s49, 4
    s_cmp_lt_u32 s49, 10
    s_cbranch_scc1 L_tile2
    s_mov_b64 exec, 1
    ds_add_u32 v119, v120 offset:1192
    s_mov_b64 exec, -1
L_tdone:
    v_bfe_u32 v20, v1, 2, 2
    v_lshrrev_b32 v21, 4, v1
    v_cmp_eq_u32 vcc, v20, v21
    v_and_b32 v22, 3, v1
    v_mov_b32 v23, 0x3f80
    v_cndmask_b32 v2, 4, v22, vcc
    v_cmp_eq_u32 vcc, 0, v2
    v_mov_b32 v24, 0
    v_and_b32 v121, 7, v1
    v_cndmask_b32 v32, 0, v23, vcc
    v_cmp_eq_u32 vcc, 1, v2
    v_mov_b32 v25, 0
    v_lshlrev_b32 v37, 4, v121
    v_cndmask_b32 v33, 0, v23, vcc
    v_cmp_eq_u32 vcc, 2, v2
    v_mov_b32 v26, 0
    v_lshrrev_b32 v116, 3, v1
    v_cndmask_b32 v34, 0, v23, vcc
    v_cmp_eq_u32 vcc, 3, v2
    v_mov_b32 v27, 0
    v_lshlrev_b32 v116, 2, v116
    v_cndmask_b32 v35, 0, v23, vcc
    v_mov_b32 v39, v37
    v_mov_b32 v41, v37
    v_mov_b32 v43, v37
    v_mov_b32 v45, v37
    v_mov_b32 v47, v37
    v_mov_b32 v49, v37
    v_mov_b32 v51, v37
    v_mov_b32 v122, 0
    v_mov_b32 v123, 0
    v_mov_b32 v124, 0
    v_mov_b32 v125, 0
    s_cmp_lt_u32 s3, 4
    s_cbranch_scc1 L_tsig
    s_branch L_join
L_e1:
    v_and_b32 v22, 3, v1
    v_lshlrev_b32 v37, 4, v1
    v_mul_u32_u24 v67, 7, v22
    s_mov_b32 s78, 0
    s_mov_b32 s54, 10
    s_movk_i32 s46, 683
    v_subrev_u32 v23, 512, v0
    v_bfe_u32 v8, v23, 2, 6
    v_and_b32 v10, 3, v23
    v_lshlrev_b32 v10, 4, v10
    v_lshl_add_u32 v11, v8, 7, v10
    v_lshl_add_u32 v21, v8, 14, v10
    v_lshl_add_u32 v65, v8, 15, v10
    v_lshlrev_b32 v62, 2, v8
    v_lshlrev_b32 v63, 2, v1
    s_bfe_u32 s50, s3, 0x10002
    s_lshl_b32 s51, s50, 6
    v_add_u32 v11, s51, v11
    s_lshl_b32 s47, s2, 6
    s_add_u32 s47, s47, 8388608
    s_lshl_b32 s52, s2, 7
    s_add_u32 s52, s52, 8388672
    s_cmp_eq_u32 s50, 0
    s_cbranch_scc1 L_lvl0
    s_add_u32 s52, s52, 2097088
    s_mov_b32 s47, s52
    v_mov_b32 v21, v65
L_lvl0:
    s_mul_i32 s51, s50, 12
    s_sub_u32 s49, s50, 1
    v_mov_b32 v60, -1
    s_mov_b64 exec, s[70:71]
    s_waitcnt vmcnt(3)
    v_mul_u32_u24 v58, 6679, v52
    v_lshrrev_b32 v58, 20, v58
    v_lshlrev_b32 v60, 2, v58
    ds_add_rtn_u32 v60, v60, v120 offset:0
    v_mul_u32_u24 v8, 157, v58
    v_sub_u32 v52, v52, v8
    v_lshlrev_b32 v58, 7, v58
    s_mov_b64 exec, -1
    s_waitcnt lgkmcnt(0)
L_round:
    v_subrev_u32 v8, s78, v60
    v_cmp_gt_u32 vcc, 24, v8
    v_mul_u32_u24 v9, s46, v8
    v_lshrrev_b32 v9, 11, v9
    v_add_u32 v10, v8, v9
    v_lshl_add_u32 v10, v10, 2, v58
    v_mad_u32_u24 v9, v9, 13, v8
    v_add_u32 v9, v9, v58
    s_mov_b64 exec, vcc
    ds_write_b8 v9, v52 offset:35084
    s_waitcnt vmcnt(0)
    v_lshl_or_b32 v8, v56, 16, v54
    ds_write_b32 v10, v8 offset:35072
    s_mov_b64 exec, 1
    ds_add_u32 v119, v120 offset:1168
    s_mov_b64 exec, -1
    s_cmp_lg_u32 s78, 0
    s_cbranch_scc1 L_havenon
    v_readfirstlane_b32 s40, v72
    v_readfirstlane_b32 s41, v73
    s_xor_b32 s77, s40, 0x4000
    s_and_b32 s77, s77, 0xc000
    s_add_u32 s40, s40, 0x7f4a7c15
    s_addc_u32 s41, s41, 0x9e3779b9
    v_lshrrev_b32 v22, v67, s40
    v_lshlrev_b32 v22, 25, v22
    v_or_b32 v7, 0x1000000, v22
    s_cmp_eq_u32 s3, 7
    s_cbranch_scc0 L_nofpre
    s_not_b32 s53, s40
    v_mov_b32 v68, s53
    s_lshl_b32 s53, s42, 6
    s_add_u32 s53, s53, s43
    s_lshl_b32 s53, s53, 7
    s_add_u32 s53, s53, 7340032
    s_mov_b64 exec, 255
    buffer_store_dwordx4 v[68:71], v37, s[28:31], s53 offen sc1
    s_mov_b64 exec, -1
    v_mov_b32 v8, s40
    v_mov_b32 v9, s41
    ds_write_b64 v119, v[8:9] offset:1184
L_nofpre:
L_havenon:
L_spin7:
    ds_read_b32 v4, v119 offset:1168
    s_waitcnt lgkmcnt(0)
    v_readfirstlane_b32 s55, v4
    s_cmp_ge_i32 s55, s54
    s_cbranch_scc0 L_spin7
    ds_read_b32 v6, v62 offset:0
    ds_read_b128 v[12:15], v11 offset:35072
    ds_read_b32 v5, v63 offset:0
    s_cmp_lt_u32 s3, 8
    s_cbranch_scc1 L_nocopy
    s_waitcnt lgkmcnt(2)
    v_subrev_u32 v6, s51, v6
    v_cmp_lt_i32 vcc, 12, v6
    v_cmp_lt_i32 s[60:61], s49, v6
    s_waitcnt lgkmcnt(1)
    v_cndmask_b32 v20, v22, v7, vcc
    v_xor_b32 v12, s77, v12
    v_xor_b32 v13, s77, v13
    v_xor_b32 v14, s77, v14
    v_or_b32 v15, v20, v15
    s_mov_b64 exec, s[60:61]
    buffer_store_dwordx4 v[12:15], v21, s[28:31], s47 offen sc1
    s_cmp_eq_u32 s50, 0
    s_cbranch_scc1 L_nofill
    s_andn2_b64 exec, exec, vcc
    buffer_store_dwordx4 v[12:15], v21, s[28:31], s47 offen offset:64 sc1
L_nofill:
    s_mov_b64 exec, 1
    ds_add_u32 v119, v120 offset:1164
    s_mov_b64 exec, -1
L_nocopy:
    s_add_u32 s78, s78, 24
    s_waitcnt lgkmcnt(0)
    v_cmp_lt_u32 vcc, s78, v5
    s_cbranch_vccnz L_again
    v_mov_b32 v66, v22
    s_cmp_ge_u32 s3, 8
    s_cbranch_scc1 L_common
    s_setprio 0
    s_waitcnt vmcnt(0)
    s_mov_b64 exec, 1
    ds_add_u32 v119, v120 offset:1216
    s_mov_b64 exec, -1
    s_branch L_common
L_c0:
    v_mov_b32 v22, v66
    v_subrev_u32 v23, 512, v0
    v_lshlrev_b32 v23, 4, v23
    v_lshlrev_b32 v21, 2, v121
    v_mov_b32 v20, 4
    v_mov_b32 v6, 0xff
    v_mov_b32 v7, 0xc000
    s_lshl_b32 s47, s43, 14
    s_add_u32 s47, s47, 8388608
    s_add_u32 s48, s47, 8192
    v_and_b32 v65, 0x1fc0, v23
    v_add_u32 v65, v65, v23
    s_lshl_b32 s49, s43, 14
    s_add_u32 s49, s49, 2097152
    s_add_u32 s50, s49, 8192
    s_mov_b32 s51, 64
    s_mov_b64 s[4:5], -1
    s_mov_b64 s[6:7], -1
    s_waitcnt vmcnt(0)
    s_branch L_spun8
L_spin8:
    s_sleep 1
L_spun8:
    ds_read_b32 v4, v119 offset:1204
    s_waitcnt lgkmcnt(0)
    v_readfirstlane_b32 s55, v4
    s_cmp_ge_i32 s55, 5
    s_cbranch_scc0 L_spin8
    s_mov_b64 exec, s[4:5]
    buffer_load_dwordx4 v[52:55], v23, s[28:31], s47 offen sc1
    s_mov_b64 exec, s[6:7]
    buffer_load_dwordx4 v[56:59], v23, s[28:31], s48 offen sc1
    s_mov_b64 exec, -1
L_cwait:
    s_waitcnt vmcnt(1)
    v_xor_b32 v68, s77, v52
    v_xor_b32 v69, s77, v53
    v_xor_b32 v70, s77, v54
    v_xor_b32 v71, v22, v55
    v_or3_b32 v8, v68, v69, v70
    v_lshrrev_b32 v9, 25, v71
    v_and_or_b32 v8, v8, v7, v9
    v_cmp_ne_u32 vcc, 0, v8
    s_and_b64 s[12:13], vcc, s[4:5]
    s_waitcnt vmcnt(0)
    v_xor_b32 v72, s77, v56
    v_xor_b32 v73, s77, v57
    v_xor_b32 v74, s77, v58
    v_xor_b32 v75, v22, v59
    v_or3_b32 v8, v72, v73, v74
    v_lshrrev_b32 v9, 25, v75
    v_and_or_b32 v8, v8, v7, v9
    v_cmp_ne_u32 vcc, 0, v8
    s_and_b64 s[14:15], vcc, s[6:7]
    s_or_b64 s[60:61], s[12:13], s[14:15]
    s_cbranch_scc1 L_cretry
    v_cmp_lt_u32 vcc, 16777215, v71
    s_mov_b64 s[8:9], s[4:5]
    s_add_u32 s47, s47, s49
    s_and_b64 s[4:5], s[4:5], vcc
    v_cmp_lt_u32 vcc, 16777215, v75
    s_mov_b64 s[10:11], s[6:7]
    s_add_u32 s48, s48, s50
    s_and_b64 s[6:7], s[6:7], vcc
    v_mov_b32 v23, v65
    s_or_b64 s[60:61], s[4:5], s[6:7]
    s_cselect_b32 s78, 1, 0
    s_cbranch_scc0 L_cnomore
    s_mov_b64 exec, s[4:5]
    buffer_load_dwordx4 v[52:55], v23, s[28:31], s47 offen sc1
    s_mov_b64 exec, s[6:7]
    buffer_load_dwordx4 v[56:59], v23, s[28:31], s48 offen sc1
    s_mov_b64 exec, -1
    s_mov_b32 s49, s51
    s_mov_b32 s50, s51
    s_sub_u32 s51, 2097152, s51
L_cnomore:
    s_mov_b64 exec, s[8:9]
    v_cmp_ne_u32_sdwa s[60:61], v71, v6 src0_sel:BYTE_0 src1_sel:DWORD
    v_lshlrev_b32_sdwa v8, 2, v71 dst_sel:DWORD dst_unused:UNUSED_PAD src0_sel:DWORD src1_sel:BYTE_0
    v_cmp_ne_u32_sdwa s[62:63], v71, v6 src0_sel:BYTE_1 src1_sel:DWORD
    v_lshlrev_b32_sdwa v9, 2, v71 dst_sel:DWORD dst_unused:UNUSED_PAD src0_sel:DWORD src1_sel:BYTE_1
    v_cmp_ne_u32_sdwa s[64:65], v71, v6 src0_sel:BYTE_2 src1_sel:DWORD
    v_lshlrev_b32_sdwa v10, 2, v71 dst_sel:DWORD dst_unused:UNUSED_PAD src0_sel:DWORD src1_sel:BYTE_2
    s_mov_b64 exec, s[10:11]
    v_cmp_ne_u32_sdwa s[66:67], v75, v6 src0_sel:BYTE_0 src1_sel:DWORD
    v_lshlrev_b32_sdwa v11, 2, v75 dst_sel:DWORD dst_unused:UNUSED_PAD src0_sel:DWORD src1_sel:BYTE_0
    v_cmp_ne_u32_sdwa s[68:69], v75, v6 src0_sel:BYTE_1 src1_sel:DWORD
    v_lshlrev_b32_sdwa v12, 2, v75 dst_sel:DWORD dst_unused:UNUSED_PAD src0_sel:DWORD src1_sel:BYTE_1
    v_cmp_ne_u32_sdwa s[70:71], v75, v6 src0_sel:BYTE_2 src1_sel:DWORD
    v_lshlrev_b32_sdwa v13, 2, v75 dst_sel:DWORD dst_unused:UNUSED_PAD src0_sel:DWORD src1_sel:BYTE_2
    s_mov_b64 exec, s[60:61]
    ds_add_rtn_u32 v14, v8, v20 offset:256
    s_mov_b64 exec, s[62:63]
    ds_add_rtn_u32 v15, v9, v20 offset:256
    s_mov_b64 exec, s[64:65]
    ds_add_rtn_u32 v16, v10, v20 offset:256
    s_mov_b64 exec, s[66:67]
    ds_add_rtn_u32 v17, v11, v20 offset:256
    s_mov_b64 exec, s[68:69]
    ds_add_rtn_u32 v18, v12, v20 offset:256
    s_mov_b64 exec, s[70:71]
    ds_add_rtn_u32 v19, v13, v20 offset:256
    s_mov_b64 exec, s[60:61]
    s_waitcnt lgkmcnt(0)
    s_cbranch_execz L_isk0
    v_min_u32 v14, 188, v14
    v_mad_u32_u24 v8, v8, 49, v14
    v_lshl_add_u32 v14, v14, 3, v21
    ds_write_b32 v8, v68 offset:3712
    ds_add_u32 v14, v20 offset:2048
L_isk0:
    s_mov_b64 exec, s[62:63]
    s_cbranch_execz L_isk1
    v_min_u32 v15, 188, v15
    v_mad_u32_u24 v9, v9, 49, v15
    v_lshl_add_u32 v15, v15, 3, v21
    ds_write_b32 v9, v69 offset:3712
    ds_add_u32 v15, v20 offset:2048
L_isk1:
    s_mov_b64 exec, s[64:65]
    s_cbranch_execz L_isk2
    v_min_u32 v16, 188, v16
    v_mad_u32_u24 v10, v10, 49, v16
    v_lshl_add_u32 v16, v16, 3, v21
    ds_write_b32 v10, v70 offset:3712
    ds_add_u32 v16, v20 offset:2048
L_isk2:
    s_mov_b64 exec, s[66:67]
    s_cbranch_execz L_isk3
    v_min_u32 v17, 188, v17
    v_mad_u32_u24 v11, v11, 49, v17
    v_lshl_add_u32 v17, v17, 3, v21
    ds_write_b32 v11, v72 offset:3712
    ds_add_u32 v17, v20 offset:2048
L_isk3:
    s_mov_b64 exec, s[68:69]
    s_cbranch_execz L_isk4
    v_min_u32 v18, 188, v18
    v_mad_u32_u24 v12, v12, 49, v18
    v_lshl_add_u32 v18, v18, 3, v21
    ds_write_b32 v12, v73 offset:3712
    ds_add_u32 v18, v20 offset:2048
L_isk4:
    s_mov_b64 exec, s[70:71]
    s_cbranch_execz L_isk5
    v_min_u32 v19, 188, v19
    v_mad_u32_u24 v13, v13, 49, v19
    v_lshl_add_u32 v19, v19, 3, v21
    ds_write_b32 v13, v74 offset:3712
    ds_add_u32 v19, v20 offset:2048
L_isk5:
    s_mov_b64 exec, -1
    s_cmp_eq_u32 s78, 1
    s_cbranch_scc1 L_cwait
L_cdone:
    s_mov_b64 exec, 1
    ds_add_u32 v119, v120 offset:1172
    s_mov_b64 exec, -1
    s_cmp_ge_u32 s3, 11
    s_cbranch_scc1 L_join0
    v_subrev_u32 v23, 512, v0
    v_cmp_gt_u32 vcc, 160, v23
    v_lshlrev_b32 v8, 2, v23
L_spin9:
    ds_read_b32 v4, v119 offset:1172
    ds_read_b32 v9, v8 offset:256
    s_waitcnt lgkmcnt(1)
    v_readfirstlane_b32 s55, v4
    s_cmp_ge_i32 s55, 8
    s_cbranch_scc0 L_spin9
    s_mov_b64 exec, vcc
    s_waitcnt lgkmcnt(0)
    v_cmp_lt_u32 vcc, 192, v9
    v_min_u32 v9, 192, v9
    ds_add_rtn_u32 v10, v9, v20 offset:896
    v_lshlrev_b32 v8, 3, v9
    ds_read_b128 v[12:15], v8 offset:2048
    ds_read_b128 v[16:19], v8 offset:2064
    v_lshl_or_b32 v11, v9, 14, v23
    s_cbranch_vccnz L_overflow
L_ovback:
    s_waitcnt lgkmcnt(1)
    v_add3_u32 v10, v10, v12, v13
    v_add3_u32 v10, v10, v14, v15
    s_waitcnt lgkmcnt(0)
    v_add3_u32 v10, v10, v16, v17
    v_add3_u32 v10, v10, v18, v19
    v_min_u32 v10, 636, v10
    ds_write_b32 v10, v11 offset:1280
    s_mov_b64 exec, 1
    ds_add_u32 v119, v120 offset:1192
    s_mov_b64 exec, -1
    s_xor_b32 s46, s3, 8
    s_or_b32 s46, s46, s2
    s_cbranch_scc1 L_join0
    s_mov_b64 exec, 1
    v_mov_b32 v8, s40
    v_mov_b32 v9, s41
    buffer_store_dwordx2 v[8:9], v119, s[28:31], 0 offen sc1
    s_mov_b64 exec, -1
L_join0:
    s_setprio 0
L_join:
    s_lshl_b32 s46, s58, 5
    v_add_u32 v5, s46, v116
    v_mov_b32 v12, 1.0
    v_mov_b32 v13, 1.0
    v_mov_b32 v14, 1.0
    v_mov_b32 v15, 1.0
    s_branch L_spun10
L_spin10:
    s_sleep 1
L_spun10:
    ds_read_b32 v7, v119 offset:1192
    ds_read_b32 v4, v5 offset:1280
    s_waitcnt lgkmcnt(1)
    v_readfirstlane_b32 s55, v7
    s_cmp_ge_i32 s55, 7
    s_cbranch_scc0 L_spin10
    ds_read_b128 v[28:31], v37 offset:1920
    s_waitcnt lgkmcnt(1)
    s_branch L_task1
L_task:
    s_lshl_b32 s46, s58, 5
    v_add_u32 v4, s46, v116
    ds_read_b32 v4, v4 offset:1280
    v_mov_b32 v12, 1.0
    v_mov_b32 v13, 1.0
    v_mov_b32 v14, 1.0
    v_mov_b32 v15, 1.0
    s_waitcnt lgkmcnt(0)
L_task1:
    s_movk_i32 s48, 272
    v_readfirstlane_b32 s46, v4
    v_and_b32 v4, 0xff, v4
    v_mul_u32_u24 v2, 196, v4
    v_mad_u32_u24 v5, v4, s48, v118
    ds_read_b128 v[20:23], v5
    s_lshr_b32 s46, s46, 16
    s_add_u32 s56, s46, 3
    s_and_b32 s49, s56, 3
    s_lshr_b32 s56, s56, 2
    s_lshl_b32 s47, s56, 4
    s_add_u32 s47, s47, 3648
    v_add_u32 v2, s47, v2
    ds_read_u16_d16_hi v24, v2 offset:34
    ds_read_u16_d16_hi v25, v2 offset:38
    ds_read_u16_d16_hi v26, v2 offset:42
    ds_read_u16_d16_hi v27, v2 offset:46
    s_cmp_ge_u32 s49, 1
    s_cselect_b32 s50, 16, 0
    v_add_u32 v17, s50, v2
    v_add_u32 v53, s50, v17
    s_cmp_ge_u32 s49, 2
    s_cselect_b32 s51, 16, 0
    v_add_u32 v18, s51, v2
    v_add_u32 v54, s51, v18
    s_cmp_ge_u32 s49, 3
    s_cselect_b32 s52, 16, 0
    v_add_u32 v19, s52, v2
    v_add_u32 v55, s52, v19
    ds_read_u16 v50, v19 offset:44
    ds_read_u16 v48, v18 offset:40
    ds_read_u16 v46, v17 offset:36
    ds_read_u16 v44, v2 offset:48
    ds_read_b32 v7, v119 offset:1176
    ds_read_u16_d16_hi v122, v2 offset:50
    ds_read_u16_d16_hi v123, v53 offset:22
    ds_read_u16_d16_hi v124, v54 offset:26
    ds_read_u16_d16_hi v125, v55 offset:30
    ds_read_b128 v[8:11], v5 offset:128
    s_cmp_lg_u32 s57, 0
    s_cselect_b32 s78, 3, 0
    s_setprio 3
    s_add_u32 s54, s56, s78
    s_cmp_ge_u32 s54, 6
    s_cbranch_scc1 L_pr1
    s_setprio 2
    s_cmp_ge_u32 s54, 4
    s_cbranch_scc1 L_pr1
    s_setprio 1
    s_cmp_ge_u32 s54, 2
    s_cbranch_scc1 L_pr1
    s_setprio 0
L_pr1:
    v_lshl_add_u32 v3, v4, 8, v117
    s_and_b32 s79, s46, 3
    s_waitcnt lgkmcnt(10)
    v_pk_fma_f32 v[112:113], v[26:27], v[28:29], v[20:21] op_sel:[1,0,0] op_sel_hi:[1,1,1]
    v_pk_fma_f32 v[114:115], v[26:27], v[30:31], v[22:23] op_sel:[1,0,0] op_sel_hi:[1,1,1]
    v_pk_fma_f32 v[108:109], v[26:27], v[28:29], v[20:21] op_sel_hi:[0,1,1]
    v_pk_fma_f32 v[110:111], v[26:27], v[30:31], v[22:23] op_sel_hi:[0,1,1]
    v_pk_fma_f32 v[104:105], v[24:25], v[28:29], v[20:21] op_sel:[1,0,0] op_sel_hi:[1,1,1]
    v_pk_fma_f32 v[106:107], v[24:25], v[30:31], v[22:23] op_sel:[1,0,0] op_sel_hi:[1,1,1]
    v_pk_fma_f32 v[100:101], v[24:25], v[28:29], v[20:21] op_sel_hi:[0,1,1]
    v_pk_fma_f32 v[102:103], v[24:25], v[30:31], v[22:23] op_sel_hi:[0,1,1]
    v_exp_f32 v112, v112
    v_exp_f32 v113, v113
    v_exp_f32 v114, v114
    v_exp_f32 v115, v115
    s_waitcnt lgkmcnt(5)
    v_readfirstlane_b32 s76, v7
    s_cmp_eq_u32 s76, 0
    s_cbranch_scc1 L_notyet
L_rdy:
    s_cmp_eq_u32 s79, 1
    s_cbranch_scc1 L_ga0
    s_cmp_eq_u32 s79, 2
    s_cbranch_scc1 L_ga1
    s_cmp_eq_u32 s79, 3
    s_cbranch_scc1 L_ga2
L_ga3:
    buffer_load_dwordx4 v[64:67], v[50:51], s[36:39], 0 idxen offen sc1
L_ga2:
    buffer_load_dwordx4 v[60:63], v[48:49], s[36:39], 0 idxen offen sc1
L_ga1:
    buffer_load_dwordx4 v[56:59], v[46:47], s[36:39], 0 idxen offen sc1
L_ga0:
    buffer_load_dwordx4 v[52:55], v[44:45], s[36:39], 0 idxen offen sc1
    s_cmp_eq_u32 s79, 0
    s_cbranch_scc1 L_gad
    buffer_load_dwordx4 v[80:83], v[50:51], s[36:39], 0 idxen offen sc1
    s_cmp_eq_u32 s79, 3
    s_cbranch_scc1 L_gad
    buffer_load_dwordx4 v[76:79], v[48:49], s[36:39], 0 idxen offen sc1
    s_cmp_eq_u32 s79, 2
    s_cbranch_scc1 L_gad
    buffer_load_dwordx4 v[72:75], v[46:47], s[36:39], 0 idxen offen sc1
L_gad:
L_notyet:
    ds_read_u16_d16_hi v24, v2 offset:18
    ds_read_u16_d16_hi v25, v17 offset:6
    ds_read_u16_d16_hi v26, v18 offset:10
    ds_read_u16_d16_hi v27, v19 offset:14
    ds_read_u16 v42, v19 offset:28
    ds_read_u16 v40, v18 offset:24
    ds_read_u16 v38, v17 offset:20
    ds_read_u16 v36, v2 offset:32
    v_exp_f32 v108, v108
    v_exp_f32 v109, v109
    v_exp_f32 v110, v110
    v_exp_f32 v111, v111
    v_exp_f32 v104, v104
    v_exp_f32 v105, v105
    v_exp_f32 v106, v106
    v_exp_f32 v107, v107
    v_exp_f32 v100, v100
    v_exp_f32 v101, v101
    v_exp_f32 v102, v102
    v_exp_f32 v103, v103
    s_waitcnt lgkmcnt(8)
    v_pk_fma_f32 v[96:97], v[124:125], v[28:29], v[20:21] op_sel:[1,0,0] op_sel_hi:[1,1,1]
    v_pk_fma_f32 v[98:99], v[124:125], v[30:31], v[22:23] op_sel:[1,0,0] op_sel_hi:[1,1,1]
    v_pk_fma_f32 v[92:93], v[124:125], v[28:29], v[20:21] op_sel_hi:[0,1,1]
    v_pk_fma_f32 v[94:95], v[124:125], v[30:31], v[22:23] op_sel_hi:[0,1,1]
    v_pk_fma_f32 v[88:89], v[122:123], v[28:29], v[20:21] op_sel:[1,0,0] op_sel_hi:[1,1,1]
    v_pk_fma_f32 v[90:91], v[122:123], v[30:31], v[22:23] op_sel:[1,0,0] op_sel_hi:[1,1,1]
    v_pk_fma_f32 v[84:85], v[122:123], v[28:29], v[20:21] op_sel_hi:[0,1,1]
    v_pk_fma_f32 v[86:87], v[122:123], v[30:31], v[22:23] op_sel_hi:[0,1,1]
    v_pk_mul_f32 v[8:9], v[8:9], s[72:73] op_sel_hi:[1,0]
    v_pk_mul_f32 v[10:11], v[10:11], s[72:73] op_sel_hi:[1,0]
    v_exp_f32 v96, v96
    v_exp_f32 v97, v97
    v_exp_f32 v98, v98
    v_exp_f32 v99, v99
    v_exp_f32 v92, v92
    v_exp_f32 v93, v93
    v_exp_f32 v94, v94
    v_exp_f32 v95, v95
    v_exp_f32 v88, v88
    v_exp_f32 v89, v89
    v_exp_f32 v90, v90
    v_exp_f32 v91, v91
    v_exp_f32 v84, v84
    v_exp_f32 v85, v85
    v_exp_f32 v86, v86
    v_exp_f32 v87, v87
    s_cmp_eq_u32 s76, 0
    s_cbranch_scc1 L_late
L_enter:
    s_cmp_lt_u32 s56, 3
    s_cbranch_scc1 L_short
    s_cmp_eq_u32 s79, 1
    s_cbranch_scc1 L_en0
    s_cmp_eq_u32 s79, 2
    s_cbranch_scc1 L_en1
    s_cmp_eq_u32 s79, 3
    s_cbranch_scc1 L_en2
    s_waitcnt vmcnt(2) lgkmcnt(0)
    v_mfma_f32_16x16x32_bf16 v[96:99], v[32:35], v[64:67], v[96:99]
    v_mfma_f32_16x16x32_bf16 v[92:95], v[32:35], v[60:63], v[92:95]
    s_nop 3
    s_nop 0
    s_nop 0
L_fx3:
    v_pk_mul_f32 v[16:17], v[64:65], v[12:13]
    v_pk_mul_f32 v[18:19], v[66:67], v[14:15]
    v_pk_fma_f32 v[8:9], v[8:9], v[96:97], v[16:17]
    v_pk_mul_f32 v[12:13], v[12:13], v[96:97]
    v_pk_fma_f32 v[10:11], v[10:11], v[98:99], v[18:19]
    v_pk_mul_f32 v[14:15], v[14:15], v[98:99]
    buffer_load_dwordx4 v[80:83], v[42:43], s[36:39], 0 idxen offen sc1
    v_pk_fma_f32 v[96:97], v[26:27], v[28:29], v[20:21] op_sel:[1,0,0] op_sel_hi:[1,1,1]
    v_pk_fma_f32 v[98:99], v[26:27], v[30:31], v[22:23] op_sel:[1,0,0] op_sel_hi:[1,1,1]
    ds_read_u16 v42, v2 offset:28
    ds_read_u16_d16_hi v27, v2 offset:14
    s_waitcnt vmcnt(2) lgkmcnt(6)
    v_mfma_f32_16x16x32_bf16 v[88:91], v[32:35], v[56:59], v[88:91]
    v_exp_f32 v96, v96
    v_exp_f32 v97, v97
    v_exp_f32 v98, v98
    v_exp_f32 v99, v99
L_fx2:
    v_pk_mul_f32 v[16:17], v[60:61], v[12:13]
    v_pk_mul_f32 v[18:19], v[62:63], v[14:15]
    v_pk_fma_f32 v[8:9], v[8:9], v[92:93], v[16:17]
    v_pk_mul_f32 v[12:13], v[12:13], v[92:93]
    v_pk_fma_f32 v[10:11], v[10:11], v[94:95], v[18:19]
    v_pk_mul_f32 v[14:15], v[14:15], v[94:95]
    buffer_load_dwordx4 v[76:79], v[40:41], s[36:39], 0 idxen offen sc1
    v_pk_fma_f32 v[92:93], v[26:27], v[28:29], v[20:21] op_sel_hi:[0,1,1]
    v_pk_fma_f32 v[94:95], v[26:27], v[30:31], v[22:23] op_sel_hi:[0,1,1]
    ds_read_u16 v40, v2 offset:24
    ds_read_u16_d16_hi v26, v2 offset:10
    s_waitcnt vmcnt(2) lgkmcnt(6)
    v_mfma_f32_16x16x32_bf16 v[84:87], v[32:35], v[52:55], v[84:87]
    v_exp_f32 v92, v92
    v_exp_f32 v93, v93
    v_exp_f32 v94, v94
    v_exp_f32 v95, v95
L_fx1:
    v_pk_mul_f32 v[16:17], v[56:57], v[12:13]
    v_pk_mul_f32 v[18:19], v[58:59], v[14:15]
    v_pk_fma_f32 v[8:9], v[8:9], v[88:89], v[16:17]
    v_pk_mul_f32 v[12:13], v[12:13], v[88:89]
    v_pk_fma_f32 v[10:11], v[10:11], v[90:91], v[18:19]
    v_pk_mul_f32 v[14:15], v[14:15], v[90:91]
    buffer_load_dwordx4 v[72:75], v[38:39], s[36:39], 0 idxen offen sc1
    v_pk_fma_f32 v[88:89], v[24:25], v[28:29], v[20:21] op_sel:[1,0,0] op_sel_hi:[1,1,1]
    v_pk_fma_f32 v[90:91], v[24:25], v[30:31], v[22:23] op_sel:[1,0,0] op_sel_hi:[1,1,1]
    ds_read_u16 v38, v2 offset:20
    ds_read_u16_d16_hi v25, v2 offset:6
    s_waitcnt vmcnt(2) lgkmcnt(6)
    v_mfma_f32_16x16x32_bf16 v[112:115], v[32:35], v[80:83], v[112:115]
    v_exp_f32 v88, v88
    v_exp_f32 v89, v89
    v_exp_f32 v90, v90
    v_exp_f32 v91, v91
L_fx0:
    v_pk_mul_f32 v[16:17], v[52:53], v[12:13]
    v_pk_mul_f32 v[18:19], v[54:55], v[14:15]
    v_pk_fma_f32 v[8:9], v[8:9], v[84:85], v[16:17]
    v_pk_mul_f32 v[12:13], v[12:13], v[84:85]
    v_pk_fma_f32 v[10:11], v[10:11], v[86:87], v[18:19]
    v_pk_mul_f32 v[14:15], v[14:15], v[86:87]
    buffer_load_dwordx4 v[68:71], v[36:37], s[36:39], 0 idxen offen sc1
    v_pk_fma_f32 v[84:85], v[24:25], v[28:29], v[20:21] op_sel_hi:[0,1,1]
    v_pk_fma_f32 v[86:87], v[24:25], v[30:31], v[22:23] op_sel_hi:[0,1,1]
    ds_read_u16 v36, v2 offset:16
    ds_read_u16_d16_hi v24, v2 offset:2
    s_waitcnt vmcnt(2) lgkmcnt(6)
    v_mfma_f32_16x16x32_bf16 v[108:111], v[32:35], v[76:79], v[108:111]
    v_exp_f32 v84, v84
    v_exp_f32 v85, v85
    v_exp_f32 v86, v86
    v_exp_f32 v87, v87
    v_subrev_u32 v2, 16, v2
    s_sub_u32 s56, s56, 1
    s_add_u32 s54, s56, s78
    s_cmp_ge_u32 s54, 6
    s_cbranch_scc1 L_pr2
    s_setprio 2
    s_cmp_ge_u32 s54, 4
    s_cbranch_scc1 L_pr2
    s_setprio 1
    s_cmp_ge_u32 s54, 2
    s_cbranch_scc1 L_pr2
    s_setprio 0
L_pr2:
    s_cmp_lt_u32 s56, 3
    s_cbranch_scc1 L_ty
L_fy3:
    v_pk_mul_f32 v[16:17], v[80:81], v[12:13]
    v_pk_mul_f32 v[18:19], v[82:83], v[14:15]
    v_pk_fma_f32 v[8:9], v[8:9], v[112:113], v[16:17]
    v_pk_mul_f32 v[12:13], v[12:13], v[112:113]
    v_pk_fma_f32 v[10:11], v[10:11], v[114:115], v[18:19]
    v_pk_mul_f32 v[14:15], v[14:15], v[114:115]
    buffer_load_dwordx4 v[64:67], v[42:43], s[36:39], 0 idxen offen sc1
    v_pk_fma_f32 v[112:113], v[26:27], v[28:29], v[20:21] op_sel:[1,0,0] op_sel_hi:[1,1,1]
    v_pk_fma_f32 v[114:115], v[26:27], v[30:31], v[22:23] op_sel:[1,0,0] op_sel_hi:[1,1,1]
    ds_read_u16 v42, v2 offset:28
    ds_read_u16_d16_hi v27, v2 offset:14
    s_waitcnt vmcnt(2) lgkmcnt(6)
    v_mfma_f32_16x16x32_bf16 v[104:107], v[32:35], v[72:75], v[104:107]
    v_exp_f32 v112, v112
    v_exp_f32 v113, v113
    v_exp_f32 v114, v114
    v_exp_f32 v115, v115
L_fy2:
    v_pk_mul_f32 v[16:17], v[76:77], v[12:13]
    v_pk_mul_f32 v[18:19], v[78:79], v[14:15]
    v_pk_fma_f32 v[8:9], v[8:9], v[108:109], v[16:17]
    v_pk_mul_f32 v[12:13], v[12:13], v[108:109]
    v_pk_fma_f32 v[10:11], v[10:11], v[110:111], v[18:19]
    v_pk_mul_f32 v[14:15], v[14:15], v[110:111]
    buffer_load_dwordx4 v[60:63], v[40:41], s[36:39], 0 idxen offen sc1
    v_pk_fma_f32 v[108:109], v[26:27], v[28:29], v[20:21] op_sel_hi:[0,1,1]
    v_pk_fma_f32 v[110:111], v[26:27], v[30:31], v[22:23] op_sel_hi:[0,1,1]
    ds_read_u16 v40, v2 offset:24
    ds_read_u16_d16_hi v26, v2 offset:10
    s_waitcnt vmcnt(2) lgkmcnt(6)
    v_mfma_f32_16x16x32_bf16 v[100:103], v[32:35], v[68:71], v[100:103]
    v_exp_f32 v108, v108
    v_exp_f32 v109, v109
    v_exp_f32 v110, v110
    v_exp_f32 v111, v111
L_fy1:
    v_pk_mul_f32 v[16:17], v[72:73], v[12:13]
    v_pk_mul_f32 v[18:19], v[74:75], v[14:15]
    v_pk_fma_f32 v[8:9], v[8:9], v[104:105], v[16:17]
    v_pk_mul_f32 v[12:13], v[12:13], v[104:105]
    v_pk_fma_f32 v[10:11], v[10:11], v[106:107], v[18:19]
    v_pk_mul_f32 v[14:15], v[14:15], v[106:107]
    buffer_load_dwordx4 v[56:59], v[38:39], s[36:39], 0 idxen offen sc1
    v_pk_fma_f32 v[104:105], v[24:25], v[28:29], v[20:21] op_sel:[1,0,0] op_sel_hi:[1,1,1]
    v_pk_fma_f32 v[106:107], v[24:25], v[30:31], v[22:23] op_sel:[1,0,0] op_sel_hi:[1,1,1]
    ds_read_u16 v38, v2 offset:20
    ds_read_u16_d16_hi v25, v2 offset:6
    s_waitcnt vmcnt(2) lgkmcnt(6)
    v_mfma_f32_16x16x32_bf16 v[96:99], v[32:35], v[64:67], v[96:99]
    v_exp_f32 v104, v104
    v_exp_f32 v105, v105
    v_exp_f32 v106, v106
    v_exp_f32 v107, v107
L_fy0:
    v_pk_mul_f32 v[16:17], v[68:69], v[12:13]
    v_pk_mul_f32 v[18:19], v[70:71], v[14:15]
    v_pk_fma_f32 v[8:9], v[8:9], v[100:101], v[16:17]
    v_pk_mul_f32 v[12:13], v[12:13], v[100:101]
    v_pk_fma_f32 v[10:11], v[10:11], v[102:103], v[18:19]
    v_pk_mul_f32 v[14:15], v[14:15], v[102:103]
    buffer_load_dwordx4 v[52:55], v[36:37], s[36:39], 0 idxen offen sc1
    v_pk_fma_f32 v[100:101], v[24:25], v[28:29], v[20:21] op_sel_hi:[0,1,1]
    v_pk_fma_f32 v[102:103], v[24:25], v[30:31], v[22:23] op_sel_hi:[0,1,1]
    ds_read_u16 v36, v2 offset:16
    ds_read_u16_d16_hi v24, v2 offset:2
    s_waitcnt vmcnt(2) lgkmcnt(6)
    v_mfma_f32_16x16x32_bf16 v[92:95], v[32:35], v[60:63], v[92:95]
    v_exp_f32 v100, v100
    v_exp_f32 v101, v101
    v_exp_f32 v102, v102
    v_exp_f32 v103, v103
    v_subrev_u32 v2, 16, v2
    s_sub_u32 s56, s56, 1
    s_add_u32 s54, s56, s78
    s_cmp_ge_u32 s54, 6
    s_cbranch_scc1 L_pr3
    s_setprio 2
    s_cmp_ge_u32 s54, 4
    s_cbranch_scc1 L_pr3
    s_setprio 1
    s_cmp_ge_u32 s54, 2
    s_cbranch_scc1 L_pr3
    s_setprio 0
L_pr3:
    s_cmp_lt_u32 s56, 3
    s_cbranch_scc0 L_fx3
L_tx:
    s_waitcnt lgkmcnt(0)
    buffer_load_dwordx4 v[80:83], v[42:43], s[36:39], 0 idxen offen sc1
    buffer_load_dwordx4 v[76:79], v[40:41], s[36:39], 0 idxen offen sc1
    buffer_load_dwordx4 v[72:75], v[38:39], s[36:39], 0 idxen offen sc1
    buffer_load_dwordx4 v[68:71], v[36:37], s[36:39], 0 idxen offen sc1
    s_cmp_lg_u32 s57, 0
    s_cbranch_scc1 L_ngdx
    s_mov_b32 s81, 1
    s_mov_b64 exec, 1
    ds_add_u32 v119, v120 offset:1196
    s_mov_b64 exec, -1
L_ngdx:
    s_waitcnt vmcnt(4)
    v_mfma_f32_16x16x32_bf16 v[88:91], v[32:35], v[56:59], v[88:91]
    v_mfma_f32_16x16x32_bf16 v[84:87], v[32:35], v[52:55], v[84:87]
    s_nop 0
L_tx3:
    v_pk_mul_f32 v[16:17], v[64:65], v[12:13]
    v_pk_mul_f32 v[18:19], v[66:67], v[14:15]
    v_pk_fma_f32 v[8:9], v[8:9], v[96:97], v[16:17]
    v_pk_mul_f32 v[12:13], v[12:13], v[96:97]
    v_pk_fma_f32 v[10:11], v[10:11], v[98:99], v[18:19]
    v_pk_mul_f32 v[14:15], v[14:15], v[98:99]
L_tx2:
    v_pk_mul_f32 v[16:17], v[60:61], v[12:13]
    v_pk_mul_f32 v[18:19], v[62:63], v[14:15]
    v_pk_fma_f32 v[8:9], v[8:9], v[92:93], v[16:17]
    v_pk_mul_f32 v[12:13], v[12:13], v[92:93]
    v_pk_fma_f32 v[10:11], v[10:11], v[94:95], v[18:19]
    v_pk_mul_f32 v[14:15], v[14:15], v[94:95]
L_tx1:
    v_pk_mul_f32 v[16:17], v[56:57], v[12:13]
    v_pk_mul_f32 v[18:19], v[58:59], v[14:15]
    v_pk_fma_f32 v[8:9], v[8:9], v[88:89], v[16:17]
    v_pk_mul_f32 v[12:13], v[12:13], v[88:89]
    v_pk_fma_f32 v[10:11], v[10:11], v[90:91], v[18:19]
    v_pk_mul_f32 v[14:15], v[14:15], v[90:91]
L_tx0:
    v_pk_mul_f32 v[16:17], v[52:53], v[12:13]
    v_pk_mul_f32 v[18:19], v[54:55], v[14:15]
    v_pk_fma_f32 v[8:9], v[8:9], v[84:85], v[16:17]
    v_pk_mul_f32 v[12:13], v[12:13], v[84:85]
    v_pk_fma_f32 v[10:11], v[10:11], v[86:87], v[18:19]
    v_pk_mul_f32 v[14:15], v[14:15], v[86:87]
    s_sub_u32 s56, s56, 1
    s_cmp_eq_u32 s56, 0
    s_cbranch_scc1 L_fin
    s_cmp_lg_u32 s78, 0
    s_cbranch_scc1 L_tpx
    s_setprio 0
L_tpx:
    s_waitcnt vmcnt(0)
    v_mfma_f32_16x16x32_bf16 v[112:115], v[32:35], v[80:83], v[112:115]
    v_mfma_f32_16x16x32_bf16 v[108:111], v[32:35], v[76:79], v[108:111]
    v_mfma_f32_16x16x32_bf16 v[104:107], v[32:35], v[72:75], v[104:107]
    v_mfma_f32_16x16x32_bf16 v[100:103], v[32:35], v[68:71], v[100:103]
    s_nop 1
    s_branch L_ty3
L_ty:
    s_waitcnt lgkmcnt(0)
    buffer_load_dwordx4 v[64:67], v[42:43], s[36:39], 0 idxen offen sc1
    buffer_load_dwordx4 v[60:63], v[40:41], s[36:39], 0 idxen offen sc1
    buffer_load_dwordx4 v[56:59], v[38:39], s[36:39], 0 idxen offen sc1
    buffer_load_dwordx4 v[52:55], v[36:37], s[36:39], 0 idxen offen sc1
    s_cmp_lg_u32 s57, 0
    s_cbranch_scc1 L_ngdy
    s_mov_b32 s81, 1
    s_mov_b64 exec, 1
    ds_add_u32 v119, v120 offset:1196
    s_mov_b64 exec, -1
L_ngdy:
    s_waitcnt vmcnt(4)
    v_mfma_f32_16x16x32_bf16 v[104:107], v[32:35], v[72:75], v[104:107]
    v_mfma_f32_16x16x32_bf16 v[100:103], v[32:35], v[68:71], v[100:103]
L_ty3:
    v_pk_mul_f32 v[16:17], v[80:81], v[12:13]
    v_pk_mul_f32 v[18:19], v[82:83], v[14:15]
    v_pk_fma_f32 v[8:9], v[8:9], v[112:113], v[16:17]
    v_pk_mul_f32 v[12:13], v[12:13], v[112:113]
    v_pk_fma_f32 v[10:11], v[10:11], v[114:115], v[18:19]
    v_pk_mul_f32 v[14:15], v[14:15], v[114:115]
L_ty2:
    v_pk_mul_f32 v[16:17], v[76:77], v[12:13]
    v_pk_mul_f32 v[18:19], v[78:79], v[14:15]
    v_pk_fma_f32 v[8:9], v[8:9], v[108:109], v[16:17]
    v_pk_mul_f32 v[12:13], v[12:13], v[108:109]
    v_pk_fma_f32 v[10:11], v[10:11], v[110:111], v[18:19]
    v_pk_mul_f32 v[14:15], v[14:15], v[110:111]
L_ty1:
    v_pk_mul_f32 v[16:17], v[72:73], v[12:13]
    v_pk_mul_f32 v[18:19], v[74:75], v[14:15]
    v_pk_fma_f32 v[8:9], v[8:9], v[104:105], v[16:17]
    v_pk_mul_f32 v[12:13], v[12:13], v[104:105]
    v_pk_fma_f32 v[10:11], v[10:11], v[106:107], v[18:19]
    v_pk_mul_f32 v[14:15], v[14:15], v[106:107]
L_ty0:
    v_pk_mul_f32 v[16:17], v[68:69], v[12:13]
    v_pk_mul_f32 v[18:19], v[70:71], v[14:15]
    v_pk_fma_f32 v[8:9], v[8:9], v[100:101], v[16:17]
    v_pk_mul_f32 v[12:13], v[12:13], v[100:101]
    v_pk_fma_f32 v[10:11], v[10:11], v[102:103], v[18:19]
    v_pk_mul_f32 v[14:15], v[14:15], v[102:103]
    s_sub_u32 s56, s56, 1
    s_cmp_eq_u32 s56, 0
    s_cbranch_scc1 L_fin
    s_cmp_lg_u32 s78, 0
    s_cbranch_scc1 L_tpy
    s_setprio 0
L_tpy:
    s_waitcnt vmcnt(0)
    v_mfma_f32_16x16x32_bf16 v[96:99], v[32:35], v[64:67], v[96:99]
    v_mfma_f32_16x16x32_bf16 v[92:95], v[32:35], v[60:63], v[92:95]
    v_mfma_f32_16x16x32_bf16 v[88:91], v[32:35], v[56:59], v[88:91]
    v_mfma_f32_16x16x32_bf16 v[84:87], v[32:35], v[52:55], v[84:87]
    s_nop 1
    s_branch L_tx3
L_en2:
    s_waitcnt vmcnt(2) lgkmcnt(0)
    v_mfma_f32_16x16x32_bf16 v[92:95], v[32:35], v[60:63], v[92:95]
    v_mfma_f32_16x16x32_bf16 v[88:91], v[32:35], v[56:59], v[88:91]
    s_nop 3
    s_branch L_fx2
L_en1:
    s_waitcnt vmcnt(2) lgkmcnt(0)
    v_mfma_f32_16x16x32_bf16 v[88:91], v[32:35], v[56:59], v[88:91]
    v_mfma_f32_16x16x32_bf16 v[84:87], v[32:35], v[52:55], v[84:87]
    s_nop 3
    s_branch L_fx1
L_en0:
    s_waitcnt vmcnt(2) lgkmcnt(0)
    v_mfma_f32_16x16x32_bf16 v[84:87], v[32:35], v[52:55], v[84:87]
    v_mfma_f32_16x16x32_bf16 v[112:115], v[32:35], v[80:83], v[112:115]
    s_nop 3
    s_branch L_fx0
L_short:
    s_cmp_eq_u32 s56, 0
    s_cbranch_scc1 L_fin
    s_waitcnt lgkmcnt(0)
    s_cmp_eq_u32 s79, 1
    s_cbranch_scc1 L_sg0
    s_cmp_eq_u32 s79, 2
    s_cbranch_scc1 L_sg1
    s_cmp_eq_u32 s79, 3
    s_cbranch_scc1 L_sg2
L_sg3:
    buffer_load_dwordx4 v[80:83], v[42:43], s[36:39], 0 idxen offen sc1
L_sg2:
    buffer_load_dwordx4 v[76:79], v[40:41], s[36:39], 0 idxen offen sc1
L_sg1:
    buffer_load_dwordx4 v[72:75], v[38:39], s[36:39], 0 idxen offen sc1
L_sg0:
    buffer_load_dwordx4 v[68:71], v[36:37], s[36:39], 0 idxen offen sc1
    s_waitcnt vmcnt(4)
    v_mfma_f32_16x16x32_bf16 v[96:99], v[32:35], v[64:67], v[96:99]
    v_mfma_f32_16x16x32_bf16 v[92:95], v[32:35], v[60:63], v[92:95]
    v_mfma_f32_16x16x32_bf16 v[88:91], v[32:35], v[56:59], v[88:91]
    v_mfma_f32_16x16x32_bf16 v[84:87], v[32:35], v[52:55], v[84:87]
    s_nop 3
    s_cmp_eq_u32 s79, 1
    s_cbranch_scc1 L_tx0
    s_cmp_eq_u32 s79, 2
    s_cbranch_scc1 L_tx1
    s_cmp_eq_u32 s79, 3
    s_cbranch_scc1 L_tx2
    s_branch L_tx3
L_late:
L_spin11:
    ds_read_b32 v7, v119 offset:1176
    s_waitcnt lgkmcnt(0)
    v_readfirstlane_b32 s55, v7
    s_cmp_ge_i32 s55, 1
    s_cbranch_scc0 L_spin11
    s_cmp_eq_u32 s79, 1
    s_cbranch_scc1 L_gb0
    s_cmp_eq_u32 s79, 2
    s_cbranch_scc1 L_gb1
    s_cmp_eq_u32 s79, 3
    s_cbranch_scc1 L_gb2
L_gb3:
    buffer_load_dwordx4 v[64:67], v[50:51], s[36:39], 0 idxen offen sc1
L_gb2:
    buffer_load_dwordx4 v[60:63], v[48:49], s[36:39], 0 idxen offen sc1
L_gb1:
    buffer_load_dwordx4 v[56:59], v[46:47], s[36:39], 0 idxen offen sc1
L_gb0:
    buffer_load_dwordx4 v[52:55], v[44:45], s[36:39], 0 idxen offen sc1
    s_cmp_eq_u32 s79, 0
    s_cbranch_scc1 L_gbd
    buffer_load_dwordx4 v[80:83], v[50:51], s[36:39], 0 idxen offen sc1
    s_cmp_eq_u32 s79, 3
    s_cbranch_scc1 L_gbd
    buffer_load_dwordx4 v[76:79], v[48:49], s[36:39], 0 idxen offen sc1
    s_cmp_eq_u32 s79, 2
    s_cbranch_scc1 L_gbd
    buffer_load_dwordx4 v[72:75], v[46:47], s[36:39], 0 idxen offen sc1
L_gbd:
    s_branch L_enter
L_fin:
    v_rcp_f32 v12, v12
    v_rcp_f32 v13, v13
    v_rcp_f32 v14, v14
    v_rcp_f32 v15, v15
    v_pk_mul_f32 v[8:9], v[8:9], v[12:13]
    v_pk_mul_f32 v[10:11], v[10:11], v[14:15]
L_fin2:
    v_pk_add_f32 v[16:17], v[8:9], v[10:11]
    v_pk_mul_f32 v[12:13], v[8:9], s[74:75] op_sel_hi:[1,0]
    v_pk_mul_f32 v[14:15], v[10:11], s[74:75] op_sel_hi:[1,0]
    v_add_f32 v16, v16, v17
    v_cmp_nlt_f32 vcc, abs(v16), s80
    v_exp_f32 v12, v12
    v_exp_f32 v13, v13
    v_exp_f32 v14, v14
    v_exp_f32 v15, v15
    s_cbranch_vccnz L_nonfin
L_finback:
    ds_read_b32 v7, v119 offset:1196
    v_pk_fma_f32 v[12:13], v[12:13], s[72:73], s[72:73] op_sel_hi:[1,0,0]
    v_pk_fma_f32 v[14:15], v[14:15], s[72:73], s[72:73] op_sel_hi:[1,0,0]
    v_rcp_f32 v12, v12
    v_rcp_f32 v13, v13
    v_rcp_f32 v14, v14
    v_rcp_f32 v15, v15
    v_pk_mul_f32 v[16:17], v[8:9], v[12:13]
    v_pk_mul_f32 v[18:19], v[10:11], v[14:15]
    v_cvt_pk_bf16_f32 v16, v16, v17
    v_cvt_pk_bf16_f32 v17, v18, v19
    s_cmp_eq_u32 s57, 0
    s_cbranch_scc1 L_last
    s_mov_b32 s58, s57
    s_mov_b32 s57, 0
    v_mov_b32 v126, v16
    v_mov_b32 v127, v17
    v_mov_b32 v121, v3
    s_branch L_task
L_last:
    s_waitcnt lgkmcnt(0)
    v_cmp_eq_u32 vcc, 16, v7
    s_cbranch_vccnz L_allg
    s_cmp_eq_u32 s81, 1
    s_cbranch_scc1 L_posted
    s_mov_b64 exec, 1
    ds_add_u32 v119, v120 offset:1196
    s_mov_b64 exec, -1
L_posted:
    s_setprio 0
    s_branch L_spun12
L_spin12:
    s_sleep 1
L_spun12:
    ds_read_b32 v4, v119 offset:1196
    s_waitcnt lgkmcnt(0)
    v_readfirstlane_b32 s55, v4
    s_cmp_ge_i32 s55, 16
    s_cbranch_scc0 L_spin12
L_allg:
    buffer_store_dwordx2 v[16:17], v3, s[24:27], 0 offen sc1 nt
    s_cmp_lt_u32 s58, 16
    s_cbranch_scc1 L_nohold
    buffer_store_dwordx2 v[126:127], v121, s[24:27], 0 offen sc1 nt
L_nohold:
    s_waitcnt lgkmcnt(0)
    s_barrier
    ds_read_b32 v4, v119 offset:1156
    s_waitcnt lgkmcnt(0)
    v_cmp_ne_u32 vcc, 0, v4
    s_cbranch_vccnz L_exact
L_end:
    s_endpgm
L_cretry:
    s_add_u32 s59, s59, 1
    s_cmp_ge_u32 s59, 32768
    s_cbranch_scc1 L_cgiveup
    s_sleep 4
    s_wqm_b64 s[12:13], s[12:13]
    s_wqm_b64 s[14:15], s[14:15]
    s_mov_b64 exec, s[12:13]
    buffer_load_dwordx4 v[52:55], v23, s[28:31], s47 offen sc1
    s_mov_b64 exec, s[14:15]
    buffer_load_dwordx4 v[56:59], v23, s[28:31], s48 offen sc1
    s_mov_b64 exec, -1
    s_branch L_cwait
L_overflow:
    ds_write_b32 v119, v120 offset:1156
    s_branch L_ovback
L_again:
    s_cmp_lt_u32 s3, 8
    s_cbranch_scc1 L_again1
    ds_write_b128 v11, v[16:19] offset:35072
    s_waitcnt lgkmcnt(0)
L_again1:
    s_mov_b64 exec, 1
    ds_add_u32 v119, v120 offset:1168
    s_mov_b64 exec, -1
    s_add_u32 s54, s54, 10
L_spin13:
    ds_read_b32 v4, v119 offset:1168
    s_waitcnt lgkmcnt(0)
    v_readfirstlane_b32 s55, v4
    s_cmp_ge_i32 s55, s54
    s_cbranch_scc0 L_spin13
    s_add_u32 s54, s54, 10
    s_add_u32 s52, s52, 2097152
    s_mov_b32 s47, s52
    v_mov_b32 v21, v65
    s_add_u32 s51, s51, 24
    s_mov_b32 s49, 0
    s_branch L_round
L_mark:
    s_waitcnt vmcnt(0)
    s_mov_b64 exec, vcc
    v_mov_b32 v50, -1
    buffer_store_dword v50, v48, s[32:35], 0 offen sc1
    s_mov_b64 exec, -1
    s_branch L_markback
L_cgiveup:
    ds_write_b32 v119, v120 offset:1156
    s_mov_b64 exec, 1
    v_mov_b32 v8, s40
    v_mov_b32 v9, s41
    buffer_store_dwordx2 v[8:9], v119, s[28:31], 0 offen sc1
    s_mov_b64 exec, -1
    s_branch L_cdone
L_pgiveup:
    ds_write_b32 v119, v120 offset:1156
    s_waitcnt vmcnt(0)
    s_branch L_pollok
L_nonfin:
    s_cmp_eq_u32 s46, 0
    s_cbranch_scc1 L_hopeless
    s_waitcnt vmcnt(0) lgkmcnt(0)
    ds_read_b128 v[8:11], v5 offset:128
    v_mul_u32_u24 v2, 196, v4
    s_waitcnt lgkmcnt(0)
    v_pk_mul_f32 v[8:9], v[8:9], s[72:73] op_sel_hi:[1,0]
    v_pk_mul_f32 v[10:11], v[10:11], s[72:73] op_sel_hi:[1,0]
L_plain:
    ds_read_u16 v36, v2 offset:3712
    ds_read_u16_d16_hi v24, v2 offset:3714
    v_add_u32 v2, 4, v2
    s_waitcnt lgkmcnt(0)
    buffer_load_dwordx4 v[52:55], v[36:37], s[36:39], 0 idxen offen sc1
    v_pk_fma_f32 v[84:85], v[24:25], v[28:29], v[20:21] op_sel_hi:[0,1,1]
    v_pk_fma_f32 v[86:87], v[24:25], v[30:31], v[22:23] op_sel_hi:[0,1,1]
    v_exp_f32 v84, v84
    v_exp_f32 v85, v85
    v_exp_f32 v86, v86
    v_exp_f32 v87, v87
    s_waitcnt vmcnt(0)
    v_lshlrev_b32 v12, 16, v52
    v_lshlrev_b32 v13, 16, v53
    v_lshlrev_b32 v14, 16, v54
    v_lshlrev_b32 v15, 16, v55
    v_add_f32 v12, v12, v84
    v_add_f32 v13, v13, v85
    v_add_f32 v14, v14, v86
    v_add_f32 v15, v15, v87
    v_max_f32 v12, 0xd800000, v12
    v_max_f32 v13, 0xd800000, v13
    v_max_f32 v14, 0xd800000, v14
    v_max_f32 v15, 0xd800000, v15
    v_rcp_f32 v12, v12
    v_rcp_f32 v13, v13
    v_rcp_f32 v14, v14
    v_rcp_f32 v15, v15
    s_sub_u32 s46, s46, 1
    v_fmac_f32 v8, v12, v52
    v_fmac_f32 v9, v13, v53
    v_fmac_f32 v10, v14, v54
    v_fmac_f32 v11, v15, v55
    s_cmp_lg_u32 s46, 0
    s_cbranch_scc1 L_plain
    s_branch L_fin2
L_hopeless:
    ds_write_b32 v119, v120 offset:1156
    s_branch L_finback
L_exact:
    s_load_dwordx2 s[6:7], s[0:1], 8
    s_load_dwordx4 s[8:11], s[0:1], 16
    s_mov_b32 s12, s44
    s_sub_u32 s13, s45, s44
    s_lshl_b32 s15, s3, 6
    s_mov_b32 s30, 0xbfb8aa3b
    v_and_b32 v2, 15, v1
    v_lshlrev_b32 v2, 1, v2
    v_bfe_u32 v3, v1, 4, 1
    v_lshl_add_u32 v2, v3, 5, v2
    v_lshrrev_b32 v3, 5, v1
    v_lshl_add_u32 v2, v3, 13, v2
    v_add_u32 v2, 43264, v2
    v_xor_b32 v3, 32, v2
    v_and_b32 v4, 31, v1
    v_lshlrev_b32 v4, 2, v4
    ds_read_b32 v5, v4 offset:1920
    v_add_u32 v4, 116992, v4
    s_waitcnt vmcnt(0) lgkmcnt(0)
    ds_read_u16 v52, v2 offset:0
    ds_read_u16 v8, v2 offset:64
    ds_read_u16 v53, v2 offset:128
    ds_read_u16 v9, v2 offset:192
    ds_read_u16 v54, v2 offset:256
    ds_read_u16 v10, v2 offset:320
    ds_read_u16 v55, v2 offset:384
    ds_read_u16 v11, v2 offset:448
    s_waitcnt lgkmcnt(0)
    v_lshl_or_b32 v52, v8, 16, v52
    v_lshl_or_b32 v53, v9, 16, v53
    v_lshl_or_b32 v54, v10, 16, v54
    v_lshl_or_b32 v55, v11, 16, v55
    ds_read_u16 v56, v3 offset:512
    ds_read_u16 v8, v3 offset:576
    ds_read_u16 v57, v3 offset:640
    ds_read_u16 v9, v3 offset:704
    ds_read_u16 v58, v3 offset:768
    ds_read_u16 v10, v3 offset:832
    ds_read_u16 v59, v3 offset:896
    ds_read_u16 v11, v3 offset:960
    s_waitcnt lgkmcnt(0)
    v_lshl_or_b32 v56, v8, 16, v56
    v_lshl_or_b32 v57, v9, 16, v57
    v_lshl_or_b32 v58, v10, 16, v58
    v_lshl_or_b32 v59, v11, 16, v59
    ds_read_u16 v60, v2 offset:1024
    ds_read_u16 v8, v2 offset:1088
    ds_read_u16 v61, v2 offset:1152
    ds_read_u16 v9, v2 offset:1216
    ds_read_u16 v62, v2 offset:1280
    ds_read_u16 v10, v2 offset:1344
    ds_read_u16 v63, v2 offset:1408
    ds_read_u16 v11, v2 offset:1472
    s_waitcnt lgkmcnt(0)
    v_lshl_or_b32 v60, v8, 16, v60
    v_lshl_or_b32 v61, v9, 16, v61
    v_lshl_or_b32 v62, v10, 16, v62
    v_lshl_or_b32 v63, v11, 16, v63
    ds_read_u16 v64, v3 offset:1536
    ds_read_u16 v8, v3 offset:1600
    ds_read_u16 v65, v3 offset:1664
    ds_read_u16 v9, v3 offset:1728
    ds_read_u16 v66, v3 offset:1792
    ds_read_u16 v10, v3 offset:1856
    ds_read_u16 v67, v3 offset:1920
    ds_read_u16 v11, v3 offset:1984
    s_waitcnt lgkmcnt(0)
    v_lshl_or_b32 v64, v8, 16, v64
    v_lshl_or_b32 v65, v9, 16, v65
    v_lshl_or_b32 v66, v10, 16, v66
    v_lshl_or_b32 v67, v11, 16, v67
    ds_read_u16 v68, v2 offset:2048
    ds_read_u16 v8, v2 offset:2112
    ds_read_u16 v69, v2 offset:2176
    ds_read_u16 v9, v2 offset:2240
    ds_read_u16 v70, v2 offset:2304
    ds_read_u16 v10, v2 offset:2368
    ds_read_u16 v71, v2 offset:2432
    ds_read_u16 v11, v2 offset:2496
    s_waitcnt lgkmcnt(0)
    v_lshl_or_b32 v68, v8, 16, v68
    v_lshl_or_b32 v69, v9, 16, v69
    v_lshl_or_b32 v70, v10, 16, v70
    v_lshl_or_b32 v71, v11, 16, v71
    ds_read_u16 v72, v3 offset:2560
    ds_read_u16 v8, v3 offset:2624
    ds_read_u16 v73, v3 offset:2688
    ds_read_u16 v9, v3 offset:2752
    ds_read_u16 v74, v3 offset:2816
    ds_read_u16 v10, v3 offset:2880
    ds_read_u16 v75, v3 offset:2944
    ds_read_u16 v11, v3 offset:3008
    s_waitcnt lgkmcnt(0)
    v_lshl_or_b32 v72, v8, 16, v72
    v_lshl_or_b32 v73, v9, 16, v73
    v_lshl_or_b32 v74, v10, 16, v74
    v_lshl_or_b32 v75, v11, 16, v75
    ds_read_u16 v76, v2 offset:3072
    ds_read_u16 v8, v2 offset:3136
    ds_read_u16 v77, v2 offset:3200
    ds_read_u16 v9, v2 offset:3264
    ds_read_u16 v78, v2 offset:3328
    ds_read_u16 v10, v2 offset:3392
    ds_read_u16 v79, v2 offset:3456
    ds_read_u16 v11, v2 offset:3520
    s_waitcnt lgkmcnt(0)
    v_lshl_or_b32 v76, v8, 16, v76
    v_lshl_or_b32 v77, v9, 16, v77
    v_lshl_or_b32 v78, v10, 16, v78
    v_lshl_or_b32 v79, v11, 16, v79
    ds_read_u16 v80, v3 offset:3584
    ds_read_u16 v8, v3 offset:3648
    ds_read_u16 v81, v3 offset:3712
    ds_read_u16 v9, v3 offset:3776
    ds_read_u16 v82, v3 offset:3840
    ds_read_u16 v10, v3 offset:3904
    ds_read_u16 v83, v3 offset:3968
    ds_read_u16 v11, v3 offset:4032
    s_waitcnt lgkmcnt(0)
    v_lshl_or_b32 v80, v8, 16, v80
    v_lshl_or_b32 v81, v9, 16, v81
    v_lshl_or_b32 v82, v10, 16, v82
    v_lshl_or_b32 v83, v11, 16, v83
    ds_read_u16 v84, v2 offset:4096
    ds_read_u16 v8, v2 offset:4160
    ds_read_u16 v85, v2 offset:4224
    ds_read_u16 v9, v2 offset:4288
    ds_read_u16 v86, v2 offset:4352
    ds_read_u16 v10, v2 offset:4416
    ds_read_u16 v87, v2 offset:4480
    ds_read_u16 v11, v2 offset:4544
    s_waitcnt lgkmcnt(0)
    v_lshl_or_b32 v84, v8, 16, v84
    v_lshl_or_b32 v85, v9, 16, v85
    v_lshl_or_b32 v86, v10, 16, v86
    v_lshl_or_b32 v87, v11, 16, v87
    ds_read_u16 v88, v3 offset:4608
    ds_read_u16 v8, v3 offset:4672
    ds_read_u16 v89, v3 offset:4736
    ds_read_u16 v9, v3 offset:4800
    ds_read_u16 v90, v3 offset:4864
    ds_read_u16 v10, v3 offset:4928
    ds_read_u16 v91, v3 offset:4992
    ds_read_u16 v11, v3 offset:5056
    s_waitcnt lgkmcnt(0)
    v_lshl_or_b32 v88, v8, 16, v88
    v_lshl_or_b32 v89, v9, 16, v89
    v_lshl_or_b32 v90, v10, 16, v90
    v_lshl_or_b32 v91, v11, 16, v91
    ds_read_u16 v92, v2 offset:5120
    ds_read_u16 v8, v2 offset:5184
    ds_read_u16 v93, v2 offset:5248
    ds_read_u16 v9, v2 offset:5312
    ds_read_u16 v94, v2 offset:5376
    ds_read_u16 v10, v2 offset:5440
    ds_read_u16 v95, v2 offset:5504
    ds_read_u16 v11, v2 offset:5568
    s_waitcnt lgkmcnt(0)
    v_lshl_or_b32 v92, v8, 16, v92
    v_lshl_or_b32 v93, v9, 16, v93
    v_lshl_or_b32 v94, v10, 16, v94
    v_lshl_or_b32 v95, v11, 16, v95
    ds_read_u16 v96, v3 offset:5632
    ds_read_u16 v8, v3 offset:5696
    ds_read_u16 v97, v3 offset:5760
    ds_read_u16 v9, v3 offset:5824
    ds_read_u16 v98, v3 offset:5888
    ds_read_u16 v10, v3 offset:5952
    ds_read_u16 v99, v3 offset:6016
    ds_read_u16 v11, v3 offset:6080
    s_waitcnt lgkmcnt(0)
    v_lshl_or_b32 v96, v8, 16, v96
    v_lshl_or_b32 v97, v9, 16, v97
    v_lshl_or_b32 v98, v10, 16, v98
    v_lshl_or_b32 v99, v11, 16, v99
    ds_read_u16 v100, v2 offset:6144
    ds_read_u16 v8, v2 offset:6208
    ds_read_u16 v101, v2 offset:6272
    ds_read_u16 v9, v2 offset:6336
    ds_read_u16 v102, v2 offset:6400
    ds_read_u16 v10, v2 offset:6464
    ds_read_u16 v103, v2 offset:6528
    ds_read_u16 v11, v2 offset:6592
    s_waitcnt lgkmcnt(0)
    v_lshl_or_b32 v100, v8, 16, v100
    v_lshl_or_b32 v101, v9, 16, v101
    v_lshl_or_b32 v102, v10, 16, v102
    v_lshl_or_b32 v103, v11, 16, v103
    ds_read_u16 v104, v3 offset:6656
    ds_read_u16 v8, v3 offset:6720
    ds_read_u16 v105, v3 offset:6784
    ds_read_u16 v9, v3 offset:6848
    ds_read_u16 v106, v3 offset:6912
    ds_read_u16 v10, v3 offset:6976
    ds_read_u16 v107, v3 offset:7040
    ds_read_u16 v11, v3 offset:7104
    s_waitcnt lgkmcnt(0)
    v_lshl_or_b32 v104, v8, 16, v104
    v_lshl_or_b32 v105, v9, 16, v105
    v_lshl_or_b32 v106, v10, 16, v106
    v_lshl_or_b32 v107, v11, 16, v107
    ds_read_u16 v108, v2 offset:7168
    ds_read_u16 v8, v2 offset:7232
    ds_read_u16 v109, v2 offset:7296
    ds_read_u16 v9, v2 offset:7360
    ds_read_u16 v110, v2 offset:7424
    ds_read_u16 v10, v2 offset:7488
    ds_read_u16 v111, v2 offset:7552
    ds_read_u16 v11, v2 offset:7616
    s_waitcnt lgkmcnt(0)
    v_lshl_or_b32 v108, v8, 16, v108
    v_lshl_or_b32 v109, v9, 16, v109
    v_lshl_or_b32 v110, v10, 16, v110
    v_lshl_or_b32 v111, v11, 16, v111
    ds_read_u16 v112, v3 offset:7680
    ds_read_u16 v8, v3 offset:7744
    ds_read_u16 v113, v3 offset:7808
    ds_read_u16 v9, v3 offset:7872
    ds_read_u16 v114, v3 offset:7936
    ds_read_u16 v10, v3 offset:8000
    ds_read_u16 v115, v3 offset:8064
    ds_read_u16 v11, v3 offset:8128
    s_waitcnt lgkmcnt(0)
    v_lshl_or_b32 v112, v8, 16, v112
    v_lshl_or_b32 v113, v9, 16, v113
    v_lshl_or_b32 v114, v10, 16, v114
    v_lshl_or_b32 v115, v11, 16, v115
L_xscan:
    v_add_u32 v8, s15, v1
    v_lshlrev_b32 v9, 1, v8
    v_lshlrev_b32 v8, 2, v8
    global_load_dword v10, v8, s[10:11]
    global_load_dword v11, v8, s[8:9]
    global_load_ushort v12, v9, s[6:7]
    s_waitcnt vmcnt(0)
    v_subrev_u32 v10, s12, v10
    v_cmp_gt_u32 s[16:17], s13, v10
    v_mul_u32_u24 v10, 272, v10
    v_lshlrev_b32 v11, 8, v11
    v_lshlrev_b32 v12, 16, v12
L_xedge:
    s_cmp_eq_u64 s[16:17], 0
    s_cbranch_scc1 L_xnext
    s_ff1_i32_b64 s18, s[16:17]
    s_bitset0_b64 s[16:17], s18
    v_readlane_b32 s19, v11, s18
    v_readlane_b32 s28, v10, s18
    v_readlane_b32 s29, v12, s18
    s_nop 3
    s_buffer_load_dwordx16 s[36:51], s[20:23], s19
    s_add_u32 s19, s19, 64
    s_buffer_load_dwordx16 s[52:67], s[20:23], s19
    s_add_u32 s19, s19, 64
    s_buffer_load_dwordx16 s[68:83], s[20:23], s19
    s_add_u32 s19, s19, 64
    s_buffer_load_dwordx16 s[84:99], s[20:23], s19
    v_add_u32 v13, s28, v4
    ds_read_b32 v14, v13
    v_mov_b32 v15, 0
    s_waitcnt lgkmcnt(0)
    v_dot2c_f32_bf16 v15, s36, v52
    v_dot2c_f32_bf16 v15, s37, v53
    v_dot2c_f32_bf16 v15, s38, v54
    v_dot2c_f32_bf16 v15, s39, v55
    v_dot2c_f32_bf16 v15, s40, v56
    v_dot2c_f32_bf16 v15, s41, v57
    v_dot2c_f32_bf16 v15, s42, v58
    v_dot2c_f32_bf16 v15, s43, v59
    v_dot2c_f32_bf16 v15, s44, v60
    v_dot2c_f32_bf16 v15, s45, v61
    v_dot2c_f32_bf16 v15, s46, v62
    v_dot2c_f32_bf16 v15, s47, v63
    v_dot2c_f32_bf16 v15, s48, v64
    v_dot2c_f32_bf16 v15, s49, v65
    v_dot2c_f32_bf16 v15, s50, v66
    v_dot2c_f32_bf16 v15, s51, v67
    v_dot2c_f32_bf16 v15, s52, v68
    v_dot2c_f32_bf16 v15, s53, v69
    v_dot2c_f32_bf16 v15, s54, v70
    v_dot2c_f32_bf16 v15, s55, v71
    v_dot2c_f32_bf16 v15, s56, v72
    v_dot2c_f32_bf16 v15, s57, v73
    v_dot2c_f32_bf16 v15, s58, v74
    v_dot2c_f32_bf16 v15, s59, v75
    v_dot2c_f32_bf16 v15, s60, v76
    v_dot2c_f32_bf16 v15, s61, v77
    v_dot2c_f32_bf16 v15, s62, v78
    v_dot2c_f32_bf16 v15, s63, v79
    v_dot2c_f32_bf16 v15, s64, v80
    v_dot2c_f32_bf16 v15, s65, v81
    v_dot2c_f32_bf16 v15, s66, v82
    v_dot2c_f32_bf16 v15, s67, v83
    v_dot2c_f32_bf16 v15, s68, v84
    v_dot2c_f32_bf16 v15, s69, v85
    v_dot2c_f32_bf16 v15, s70, v86
    v_dot2c_f32_bf16 v15, s71, v87
    v_dot2c_f32_bf16 v15, s72, v88
    v_dot2c_f32_bf16 v15, s73, v89
    v_dot2c_f32_bf16 v15, s74, v90
    v_dot2c_f32_bf16 v15, s75, v91
    v_dot2c_f32_bf16 v15, s76, v92
    v_dot2c_f32_bf16 v15, s77, v93
    v_dot2c_f32_bf16 v15, s78, v94
    v_dot2c_f32_bf16 v15, s79, v95
    v_dot2c_f32_bf16 v15, s80, v96
    v_dot2c_f32_bf16 v15, s81, v97
    v_dot2c_f32_bf16 v15, s82, v98
    v_dot2c_f32_bf16 v15, s83, v99
    v_dot2c_f32_bf16 v15, s84, v100
    v_dot2c_f32_bf16 v15, s85, v101
    v_dot2c_f32_bf16 v15, s86, v102
    v_dot2c_f32_bf16 v15, s87, v103
    v_dot2c_f32_bf16 v15, s88, v104
    v_dot2c_f32_bf16 v15, s89, v105
    v_dot2c_f32_bf16 v15, s90, v106
    v_dot2c_f32_bf16 v15, s91, v107
    v_dot2c_f32_bf16 v15, s92, v108
    v_dot2c_f32_bf16 v15, s93, v109
    v_dot2c_f32_bf16 v15, s94, v110
    v_dot2c_f32_bf16 v15, s95, v111
    v_dot2c_f32_bf16 v15, s96, v112
    v_dot2c_f32_bf16 v15, s97, v113
    v_dot2c_f32_bf16 v15, s98, v114
    v_dot2c_f32_bf16 v15, s99, v115
    v_fmac_f32 v14, s29, v5
    s_nop 1
    v_mov_b32 v16, v15
    s_nop 1
    v_permlane32_swap_b32 v15, v16
    s_nop 1
    v_fmac_f32 v14, s30, v15
    v_exp_f32 v14, v14
    s_nop 0
    v_add_f32 v14, 1.0, v14
    v_rcp_f32 v14, v14
    s_nop 0
    v_mul_f32 v14, v14, v16
    s_mov_b32 exec_hi, 0
    ds_add_f32 v13, v14 offset:128
    s_mov_b64 exec, -1
    s_branch L_xedge
L_xnext:
    s_add_u32 s15, s15, 1024
    s_cmp_lt_u32 s15, 160000
    s_cbranch_scc1 L_xscan
    s_waitcnt lgkmcnt(0)
    s_barrier
    s_mov_b32 s15, s3
    v_lshrrev_b32 v8, 3, v0
L_xout:
    v_mul_u32_u24 v9, 272, v8
    v_add_u32 v9, v9, v118
    ds_read_b128 v[12:15], v9 offset:128
    v_lshl_add_u32 v10, v8, 8, v117
    s_waitcnt lgkmcnt(0)
    v_mul_f32 v16, s30, v12
    v_mul_f32 v17, s30, v13
    v_mul_f32 v18, s30, v14
    v_mul_f32 v19, s30, v15
    v_exp_f32 v16, v16
    v_exp_f32 v17, v17
    v_exp_f32 v18, v18
    v_exp_f32 v19, v19
    v_add_f32 v16, 1.0, v16
    v_add_f32 v17, 1.0, v17
    v_add_f32 v18, 1.0, v18
    v_add_f32 v19, 1.0, v19
    v_rcp_f32 v16, v16
    v_rcp_f32 v17, v17
    v_rcp_f32 v18, v18
    v_rcp_f32 v19, v19
    v_mul_f32 v16, v12, v16
    v_mul_f32 v17, v13, v17
    v_mul_f32 v18, v14, v18
    v_mul_f32 v19, v15, v19
    v_cvt_pk_bf16_f32 v16, v16, v17
    v_cvt_pk_bf16_f32 v17, v18, v19
    buffer_store_dwordx2 v[16:17], v10, s[24:27], 0 offen sc1
    v_add_u32 v8, 128, v8
    s_add_u32 s15, s15, 16
    s_cmp_lt_u32 s15, 20
    s_cbranch_scc1 L_xout
    s_endpgm
.section .rodata,"a"
.p2align 6
.amdhsa_kernel gather_scatter__edge_featured_mpnn_egc__graph_kernel
  .amdhsa_next_free_vgpr 128
  .amdhsa_next_free_sgpr 102
  .amdhsa_accum_offset 128
  .amdhsa_group_segment_fixed_size 0
  .amdhsa_kernarg_size 80
  .amdhsa_user_sgpr_count 2
  .amdhsa_user_sgpr_kernarg_segment_ptr 1
  .amdhsa_system_sgpr_workgroup_id_x 1
.end_amdhsa_kernel
```
